```python
import torch

def _softmax(x, axis=-1):
    return torch.softmax(x, dim=axis)
def _gelu(x):
    return torch.nn.functional.gelu(x, approximate="tanh")
def _silu(x):
    return torch.nn.functional.silu(x)
def _sigmoid(x):
    return torch.sigmoid(x)
def _layernorm(x, axis=-1, eps=1e-5):
    m = x.mean(dim=axis, keepdim=True)
    v = x.var(dim=axis, keepdim=True, unbiased=False)
    return (x - m) / torch.sqrt(v + eps)
def _scatter_add(tgt, idx, src, axis=0):
    return tgt.clone().index_add_(axis, idx, src)
def _segment_sum(src, seg, n):
    out = torch.zeros((n,) + src.shape[1:], dtype=src.dtype)
    return out.index_add_(0, seg, src)
def _pad(x, pw):
    flat = tuple(v for pair in reversed(pw) for v in pair)
    return torch.nn.functional.pad(x, flat)

kernel_name = 'sequential_preLN__sliding_local_dilated__dense_activation_relu__prompt'

def setup_inputs():

    _w = (lambda a: (lambda t: t.to(torch.bfloat16) if t.is_floating_point() else t)(torch.as_tensor(a)))
    def _A_setup():
        B, S, D = 1, 2048, 448
        return {
            "x": _w((lambda *s: torch.randn(*s, dtype=torch.bfloat16) * 0.05)(B, S, D)),
            "wqkv": _w((lambda *s: torch.randn(*s, dtype=torch.bfloat16) * 0.05)(D, 3 * D)),
            "wo": _w((lambda *s: torch.randn(*s, dtype=torch.bfloat16) * 0.05)(D, D)),
        }
    _A_in = _A_setup()

    def _B_setup():
        B, S, D, Dff = 1, 2048, 448, 1792
        return {
            "x": _w((lambda *s: torch.randn(*s, dtype=torch.bfloat16) * 0.05)(B, S, D)),
            "w1": _w((lambda *s: torch.randn(*s, dtype=torch.bfloat16) * 0.05)(D, Dff)),
            "w2": _w((lambda *s: torch.randn(*s, dtype=torch.bfloat16) * 0.05)(Dff, D)),
        }
    _B_in = _B_setup()

    return {
        "A_x": _A_in["x"],
        "A_wqkv": _A_in["wqkv"],
        "A_wo": _A_in["wo"],
        "B_x": _B_in["x"],
        "B_w1": _B_in["w1"],
        "B_w2": _B_in["w2"],
    }

def reference(A_x, A_wqkv, A_wo, B_x, B_w1, B_w2):
    def _A_ref(x, wqkv, wo):
        B, S, D = x.shape
        H = 16; Dh = D // H
        W, dil = 8, 2
        qkv = (lambda x, *d: x.permute(*d))((x @ wqkv).reshape(B, S, 3, H, Dh), 2, 0, 3, 1, 4)
        q, k, v = qkv[0], qkv[1], qkv[2]
        scale = Dh ** -0.5
        pos = torch.arange(S)
        off = torch.arange(W) * dil
        idx = pos[:, None] - off[None, :]
        mask = idx >= 0
        idx_c = torch.where(mask, idx, 0).reshape(-1)
        kg = k[:, :, idx_c, :].reshape(B, H, S, W, Dh)
        vg = v[:, :, idx_c, :].reshape(B, H, S, W, Dh)
        logits = torch.einsum("bhsd,bhswd->bhsw", q, kg) * scale
        logits = torch.where(mask[None, None, :, :], logits, -1e9)
        attn = _softmax(logits, axis=-1)
        o = torch.einsum("bhsw,bhswd->bhsd", attn, vg)
        return (lambda x, *d: x.permute(*d))(o, 0, 2, 1, 3).reshape(B, S, D) @ wo

    def _B_ref(x, w1, w2):
        h = torch.einsum("bsd,df->bsf", x, w1)
        zero = torch.zeros_like(h)
        h = torch.maximum(h, zero)
        return torch.einsum("bsf,fd->bsd", h, w2)

    x = A_x
    h = x + _A_ref(_layernorm(x, axis=-1), A_wqkv, A_wo)
    h2 = h + _B_ref(_layernorm(h, axis=-1), B_w1, B_w2)
    return h2
```

```asm
; @launch grid=(256,1,1) block=(256,1,1) lds=163840
.amdgcn_target "amdgcn-amd-amdhsa--gfx950"
.text
.globl sequential_preLN__sliding_local_dilated__dense_activation_relu__prompt_kernel
.p2align 8
.type sequential_preLN__sliding_local_dilated__dense_activation_relu__prompt_kernel,@function
sequential_preLN__sliding_local_dilated__dense_activation_relu__prompt_kernel:
    s_cmp_ge_u32 s2, 256
    s_cbranch_scc1 L_end
    s_load_dwordx2 s[4:5], s[0:1], 0
    s_load_dwordx2 s[8:9], s[0:1], 8
    s_load_dwordx2 s[28:29], s[0:1], 64
    s_load_dwordx2 s[12:13], s[0:1], 16
    s_load_dwordx2 s[16:17], s[0:1], 32
    s_load_dwordx2 s[20:21], s[0:1], 40
    s_load_dwordx2 s[24:25], s[0:1], 48
    s_getpc_b64 s[100:101]
L_pfbase:
    v_lshlrev_b32 v88, 7, v0
    v_add_u32 v89, 0x8000, v88
    v_min_u32 v88, L_codeend-L_pfbase-4, v88
    v_min_u32 v89, L_codeend-L_pfbase-4, v89
    global_load_dword v90, v88, s[100:101]
    global_load_dword v91, v89, s[100:101]
    s_mov_b32 s6, 1835008
    s_mov_b32 s7, 0x20000
    s_mov_b32 s10, 1204224
    s_mov_b32 s11, 0x20000
    s_mov_b32 s14, 401408
    s_mov_b32 s15, 0x20000
    s_mov_b32 s18, 1605632
    s_mov_b32 s19, 0x20000
    s_mov_b32 s22, 1605632
    s_mov_b32 s23, 0x20000
    s_mov_b32 s26, 1835008
    s_mov_b32 s27, 0x20000
    s_mov_b32 s30, 16777216
    s_mov_b32 s31, 0x20000
    s_and_b32 s40, s2, 7
    s_lshr_b32 s41, s2, 3
    s_and_b32 s33, s41, 15
    s_lshr_b32 s41, s41, 4
    s_lshl_b32 s40, s40, 1
    s_add_u32 s32, s40, s41
    s_lshl_b32 s38, s32, 7
    v_lshrrev_b32 v1, 6, v0
    v_and_b32 v0, 63, v0
    v_readfirstlane_b32 s34, v1
    s_getreg_b32 s36, hwreg(HW_REG_XCC_ID, 0, 4)
    v_and_b32 v17, 15, v0
    v_lshrrev_b32 v18, 4, v0
    s_lshl_b32 s40, s2, 2
    s_add_u32 s40, s40, s34
    s_mul_i32 s41, s40, 13
    v_add_u32 v96, s41, v0
    v_lshlrev_b32 v96, 7, v96
    s_mul_i32 s41, s40, 10
    v_add_u32 v97, s41, v0
    v_lshlrev_b32 v97, 7, v97
    s_lshl_b32 s41, s40, 2
    v_add_u32 v98, s41, v0
    v_lshlrev_b32 v98, 7, v98
    s_sub_u32 s41, s38, 16
    s_mul_i32 s41, s41, 7
    s_lshl_b32 s42, s33, 2
    s_add_u32 s42, s42, s34
    s_lshl_b32 s42, s42, 4
    s_add_u32 s41, s41, s42
    v_add_u32 v99, s41, v0
    v_lshlrev_b32 v99, 7, v99
    v_lshrrev_b32 v19, 3, v0
    v_mul_u32_u24 v19, 896, v19
    v_and_b32 v20, 7, v0
    v_xor_b32 v21, v20, v18
    v_lshl_add_u32 v1, v21, 4, v19
    v_xor_b32 v2, 64, v1
    s_lshl_b32 s41, s34, 5
    s_add_u32 s41, s41, s38
    s_mul_i32 s44, s41, 896
    s_add_u32 s45, s44, 7168
    s_add_u32 s46, s44, 14336
    s_add_u32 s47, s44, 21504
    s_lshl_b32 s48, s34, 12
    s_add_u32 s48, s48, 2048
    s_waitcnt lgkmcnt(0)
    s_mov_b64 exec, 0xffff
    buffer_load_dword a240, v99, s[4:7], 0 offen
    s_mov_b64 exec, 0x3ff
    buffer_load_dword a241, v97, s[8:11], 0 offen
    s_mov_b64 exec, -1
    s_add_u32 m0, s48, 61440
    s_nop 0
    buffer_load_dwordx4 v1, s[4:7], s44 offen offset:0 lds
    s_add_u32 m0, s48, 62464
    s_nop 0
    buffer_load_dwordx4 v2, s[4:7], s45 offen offset:0 lds
    s_add_u32 m0, s48, 63488
    s_nop 0
    buffer_load_dwordx4 v1, s[4:7], s46 offen offset:0 lds
    s_add_u32 m0, s48, 64512
    s_nop 0
    buffer_load_dwordx4 v2, s[4:7], s47 offen offset:0 lds
    s_lshr_b32 s41, s34, 1
    s_lshl_b32 s41, s41, 5
    s_and_b32 s42, s34, 1
    s_lshl_b32 s42, s42, 2
    s_add_u32 s41, s41, s42
    v_bfe_u32 v19, v0, 2, 2
    v_lshl_add_u32 v19, v18, 3, v19
    v_add_u32 v19, s41, v19
    v_mul_u32_u24 v19, 2688, v19
    v_and_b32 v20, 1, v18
    v_lshlrev_b32 v20, 1, v20
    v_and_b32 v21, 3, v0
    v_xor_b32 v21, v21, v20
    v_lshl_add_u32 v19, v21, 4, v19
    s_mul_i32 s41, s33, 56
    v_add_u32 v4, s41, v19
    s_mul_i32 s50, s34, 3072
    s_add_u32 s50, s50, 18432
    s_mov_b32 s54, 0
    s_add_u32 m0, s50, 61440
    s_nop 0
    buffer_load_dwordx4 v4, s[8:11], s54 offen offset:0 lds
    s_add_u32 m0, s50, 61568
    s_nop 0
    buffer_load_dwordx4 v4, s[8:11], s54 offen offset:896 lds
    s_add_u32 m0, s50, 61696
    s_nop 0
    buffer_load_dwordx4 v4, s[8:11], s54 offen offset:1792 lds
    v_lshrrev_b32 v19, 3, v0
    v_mul_u32_u24 v19, 896, v19
    v_and_b32 v20, 7, v0
    s_lshl_b32 s41, s34, 1
    v_add_u32 v21, s41, v18
    v_and_b32 v21, 7, v21
    v_xor_b32 v21, v20, v21
    v_lshl_add_u32 v3, v21, 4, v19
    s_lshl_b32 s42, s34, 2
    s_sub_u32 s43, s38, 16
    s_add_u32 s41, s43, s42
    s_mul_i32 s41, s41, 896
    v_add_u32 v3, s41, v3
    s_lshl_b32 s49, s34, 9
    s_mov_b32 s52, -1
    s_mov_b32 s53, 0
    s_cmp_eq_u32 s34, 0
    s_cselect_b32 s52, 0xffffff00, s52
    s_mov_b32 s55, 0
    s_add_u32 m0, s49, 61440
    s_mov_b64 exec, s[52:53]
    buffer_load_dwordx4 v3, s[4:7], s55 offen lds
    s_mov_b64 exec, -1
    s_lshl_b32 s40, s32, 12
    v_mov_b32 v208, s40
    s_mul_i32 s41, s33, 9
    s_lshl_b32 s42, s34, 2
    v_add_u32 v20, s42, v18
    v_add_u32 v21, s41, v20
    s_sub_u32 s43, s38, 16
    v_add_u32 v22, s43, v21
    v_mul_u32_u24 v22, 896, v22
    v_lshl_add_u32 v22, v17, 4, v22
    v_cmp_gt_u32 s[100:101], 9, v20
    v_cmp_gt_u32 s[42:43], 14, v17
    s_nop 0
    s_and_b64 s[42:43], s[42:43], s[100:101]
    v_mov_b32 v23, 0x80000000
    v_cndmask_b32 v210, v23, v22, s[42:43]
    v_lshlrev_b32 v21, 4, v21
    s_add_u32 s41, s40, 65536
    v_add_u32 v21, s41, v21
    v_cmp_eq_u32 s[42:43], 0, v17
    s_nop 0
    s_and_b64 s[42:43], s[42:43], s[100:101]
    s_nop 0
    v_cndmask_b32 v209, v23, v21, s[42:43]
    buffer_load_dword v208, v208, s[28:31], 0 offen sc1
    buffer_load_dwordx4 v[192:195], v210, s[4:7], 0 offen offset:0
    buffer_load_dwordx4 v[196:199], v210, s[4:7], 0 offen offset:224
    buffer_load_dwordx4 v[200:203], v210, s[4:7], 0 offen offset:448
    buffer_load_dwordx4 v[204:207], v210, s[4:7], 0 offen offset:672
    v_and_b32 v19, 7, v0
    v_lshlrev_b32 v19, 4, v19
    v_mov_b32 v132, 0x3f803f80
    v_mov_b32 v133, 0x3f803f80
    v_mov_b32 v134, 0x3f803f80
    v_mov_b32 v135, 0x3f803f80
    ds_write_b128 v19, v[132:135]
    ds_write_b128 v19, v[132:135] offset:30720
    ds_write_b128 v19, v[132:135] offset:61440
    v_add_u32 v20, 105984, v19
    ds_write_b128 v20, v[132:135]
    v_mov_b32 v136, 0
    v_mov_b32 v137, 0
    v_lshlrev_b32 v20, 3, v0
    v_add_u32 v20, 163328, v20
    ds_write_b64 v20, v[136:137]
    v_lshrrev_b32 v19, 1, v17
    v_xor_b32 v19, v19, v18
    v_lshlrev_b32 v19, 4, v19
    v_lshl_add_u32 v7, v17, 7, v19
    v_xor_b32 v8, 64, v7
    v_add_u32 v5, s48, v7
    s_add_u32 m0, s48, -128
    s_nop 0
    buffer_load_dwordx4 v1, s[4:7], s44 offen offset:128 lds
    v_add_u32 v6, s48, v8
    v_lshrrev_b32 v19, 2, v0
    v_lshlrev_b32 v19, 6, v19
    v_bfe_u32 v20, v0, 1, 1
    v_bfe_u32 v21, v0, 4, 1
    v_lshlrev_b32 v21, 1, v21
    v_xor_b32 v20, v20, v21
    v_lshl_add_u32 v19, v20, 4, v19
    v_and_b32 v20, 1, v0
    v_lshl_add_u32 v19, v20, 3, v19
    s_lshl_b32 s40, s34, 11
    s_add_u32 s40, s40, 66560
    v_add_u32 v210, s40, v19
    v_xor_b32 v211, 32, v210
    v_add_u32 v9, 18432, v19
    v_xor_b32 v10, 32, v9
    s_and_b32 s40, s34, 1
    s_lshl_b32 s40, s40, 5
    v_xor_b32 v12, s40, v9
    s_lshr_b32 s40, s34, 1
    s_add_u32 s40, s40, 1
    s_lshl_b32 s40, s40, 10
    v_add_u32 v11, s40, v12
    s_add_u32 m0, s48, 896
    s_nop 0
    buffer_load_dwordx4 v2, s[4:7], s45 offen offset:128 lds
    v_add_u32 v13, 61440, v9
    v_add_u32 v14, 61440, v10
    v_add_u32 v15, 61440, v11
    v_add_u32 v16, 61440, v12
    v_lshlrev_b32 v19, 4, v18
    v_add_u32 v26, 100352, v19
    s_add_u32 s40, s34, 2
    s_lshl_b32 s40, s40, 6
    v_add_u32 v24, s40, v26
    s_and_b32 s40, s34, 1
    s_lshl_b32 s40, s40, 6
    v_add_u32 v25, s40, v26
    v_lshrrev_b32 v19, 1, v18
    v_bfe_u32 v20, v17, 2, 1
    v_lshlrev_b32 v20, 1, v20
    v_xor_b32 v19, v19, v20
    v_lshlrev_b32 v19, 4, v19
    v_lshl_add_u32 v19, v17, 6, v19
    v_and_b32 v20, 1, v18
    v_lshl_add_u32 v19, v20, 3, v19
    s_lshl_b32 s40, s34, 11
    s_add_u32 s40, s40, 67584
    v_add_u32 v28, s40, v19
    s_add_u32 m0, s48, 1920
    s_nop 0
    buffer_load_dwordx4 v1, s[4:7], s46 offen offset:128 lds
    v_xor_b32 v29, 32, v28
    s_and_b32 s40, s34, 1
    s_lshl_b32 s41, s40, 5
    v_xor_b32 v19, s41, v19
    v_add_u32 v19, 66560, v19
    v_lshlrev_b32 v30, 4, v0
    s_lshl_b32 s41, s40, 3
    s_add_u32 s41, s41, 61440
    v_add_u32 v20, s41, v30
    s_cmp_lt_u32 s34, 2
    s_cselect_b64 s[42:43], -1, 0
    v_cndmask_b32 v27, v19, v20, s[42:43]
    s_lshl_b32 s40, s34, 10
    s_add_u32 s40, s40, 61440
    v_add_u32 v30, s40, v30
    s_lshl_b32 s40, s32, 12
    s_add_u32 s40, s40, 65536
    v_lshlrev_b32 v23, 4, v17
    v_add_u32 v23, s40, v23
    s_lshl_b32 s40, s32, 17
    s_lshl_b32 s41, s34, 15
    s_add_u32 s40, s40, s41
    s_lshl_b32 s41, s33, 10
    s_add_u32 s40, s40, s41
    s_add_u32 s40, s40, 1048576
    v_lshlrev_b32 v31, 4, v0
    s_add_u32 m0, s48, 2944
    s_nop 0
    buffer_load_dwordx4 v2, s[4:7], s47 offen offset:128 lds
    v_add_u32 v31, s40, v31
    v_cmp_eq_u32 s[98:99], 3, v18
    s_cmp_ge_u32 s33, 7
    s_cselect_b32 s57, 1, 0
    s_mul_i32 s58, s57, 7
    s_sub_u32 s58, s33, s58
    s_lshr_b32 s59, s34, 1
    s_and_b32 s60, s34, 1
    s_lshl_b32 s61, s57, 2
    s_lshl_b32 s69, s60, 1
    s_add_u32 s61, s61, s69
    s_add_u32 s61, s61, s59
    s_lshl_b32 s62, s34, 10
    s_mul_i32 s65, s34, 7168
    s_lshr_b32 s63, s34, 1
    s_add_u32 s63, s63, 1
    s_mul_i32 s63, s63, 86016
    s_add_u32 s63, s63, s65
    s_mul_i32 s64, s34, 1792
    s_mov_b32 s66, -1
    s_mov_b32 s67, 0xffff
    v_lshrrev_b32 v19, 3, v0
    s_mov_b32 s54, 172032
    s_add_u32 m0, s50, 0
    s_nop 0
    buffer_load_dwordx4 v4, s[8:11], s54 offen offset:0 lds
    v_mul_u32_u24 v19, 896, v19
    v_lshlrev_b32 v20, 1, v18
    v_and_b32 v21, 7, v0
    v_xor_b32 v20, v20, v21
    v_lshl_add_u32 v19, v20, 4, v19
    s_lshl_b32 s69, s58, 7
    v_add_u32 v252, s69, v19
    s_mul_i32 s69, s34, 28672
    s_mul_i32 s68, s33, 224
    s_add_u32 s69, s69, s68
    v_add_u32 v19, 0, v0
    v_mul_u32_u24 v20, 4682, v19
    v_lshrrev_b32 v20, 16, v20
    v_mul_u32_u24 v21, 14, v20
    v_sub_u32 v21, v19, v21
    v_mul_u32_u24 v20, 3584, v20
    v_lshl_add_u32 v253, v21, 4, v20
    v_add_u32 v253, s69, v253
    v_add_u32 v19, 64, v0
    v_mul_u32_u24 v20, 4682, v19
    v_lshrrev_b32 v20, 16, v20
    v_mul_u32_u24 v21, 14, v20
    s_add_u32 m0, s50, 128
    s_nop 0
    buffer_load_dwordx4 v4, s[8:11], s54 offen offset:896 lds
    v_sub_u32 v21, v19, v21
    v_mul_u32_u24 v20, 3584, v20
    v_lshl_add_u32 v254, v21, 4, v20
    v_add_u32 v254, s69, v254
    s_waitcnt vmcnt(10)
    v_readfirstlane_b32 s35, v208
    s_nop 0
    s_mul_i32 s35, s35, 0x9E3779B1
    s_add_u32 s35, s35, 0x7F4A7C15
    v_mov_b32 v19, 0
    v_mov_b32 v20, 0
    v_mov_b32 v21, 0x3f803f80
    s_waitcnt vmcnt(9)
    v_dot2c_f32_bf16 v19, v192, v21
    v_dot2c_f32_bf16 v20, v192, v192
    v_dot2c_f32_bf16 v19, v193, v21
    v_dot2c_f32_bf16 v20, v193, v193
    v_dot2c_f32_bf16 v19, v194, v21
    v_dot2c_f32_bf16 v20, v194, v194
    v_dot2c_f32_bf16 v19, v195, v21
    v_dot2c_f32_bf16 v20, v195, v195
    s_waitcnt vmcnt(8)
    v_dot2c_f32_bf16 v19, v196, v21
    v_dot2c_f32_bf16 v20, v196, v196
    v_dot2c_f32_bf16 v19, v197, v21
    v_dot2c_f32_bf16 v20, v197, v197
    s_add_u32 m0, s50, 256
    s_nop 0
    buffer_load_dwordx4 v4, s[8:11], s54 offen offset:1792 lds
    v_dot2c_f32_bf16 v19, v198, v21
    v_dot2c_f32_bf16 v20, v198, v198
    v_dot2c_f32_bf16 v19, v199, v21
    v_dot2c_f32_bf16 v20, v199, v199
    s_waitcnt vmcnt(8)
    v_dot2c_f32_bf16 v19, v200, v21
    v_dot2c_f32_bf16 v20, v200, v200
    v_dot2c_f32_bf16 v19, v201, v21
    v_dot2c_f32_bf16 v20, v201, v201
    v_dot2c_f32_bf16 v19, v202, v21
    v_dot2c_f32_bf16 v20, v202, v202
    v_dot2c_f32_bf16 v19, v203, v21
    v_dot2c_f32_bf16 v20, v203, v203
    s_waitcnt vmcnt(7)
    v_dot2c_f32_bf16 v19, v204, v21
    v_dot2c_f32_bf16 v20, v204, v204
    v_dot2c_f32_bf16 v19, v205, v21
    v_dot2c_f32_bf16 v20, v205, v205
    v_dot2c_f32_bf16 v19, v206, v21
    v_dot2c_f32_bf16 v20, v206, v206
    v_dot2c_f32_bf16 v19, v207, v21
    v_dot2c_f32_bf16 v20, v207, v207
    s_nop 1
    v_add_f32_dpp v19, v19, v19 row_ror:8 row_mask:0xf bank_mask:0xf
    s_nop 1
    v_add_f32_dpp v20, v20, v20 row_ror:8 row_mask:0xf bank_mask:0xf
    s_mov_b32 s55, 128
    s_add_u32 m0, s49, 0
    s_mov_b64 exec, s[52:53]
    buffer_load_dwordx4 v3, s[4:7], s55 offen lds
    s_mov_b64 exec, -1
    v_add_f32_dpp v19, v19, v19 row_ror:4 row_mask:0xf bank_mask:0xf
    v_add_f32_dpp v20, v20, v20 row_ror:4 row_mask:0xf bank_mask:0xf
    s_nop 0
    v_add_f32_dpp v19, v19, v19 row_ror:2 row_mask:0xf bank_mask:0xf
    s_nop 0
    v_add_f32_dpp v20, v20, v20 row_ror:2 row_mask:0xf bank_mask:0xf
    s_nop 0
    v_add_f32_dpp v19, v19, v19 row_ror:1 row_mask:0xf bank_mask:0xf
    s_nop 0
    v_add_f32_dpp v20, v20, v20 row_ror:1 row_mask:0xf bank_mask:0xf
    v_mul_f32 v204, -0.002232142857142857, v19
    v_mul_f32 v20, 0.002232142857142857, v20
    v_fma_f32 v20, -v204, v204, v20
    v_max_f32 v20, 0, v20
    v_add_f32 v20, 0x3727c5ac, v20
    v_rsq_f32 v205, v20
    v_mov_b32 v206, s35
    v_mov_b32 v207, s36
    buffer_store_dwordx4 v[204:207], v209, s[28:31], 0 offen sc1
    v_lshlrev_b32 v19, 2, v18
    v_sub_u32 v19, v17, v19
    v_mov_b32 v22, 0xf149f2ca
    v_subrev_u32 v20, 0, v19
    v_and_b32 v21, 1, v20
    v_cmp_eq_u32 s[42:43], 0, v21
    v_cmp_le_i32 s[40:41], 0, v20
    v_cmp_ge_i32 s[100:101], -2, v20
    s_and_b64 s[40:41], s[40:41], s[42:43]
    s_and_b64 s[100:101], s[100:101], s[42:43]
    v_cndmask_b32 v196, v22, 0, s[40:41]
    s_add_u32 m0, s48, 30464
    s_nop 0
    buffer_load_dwordx4 v1, s[4:7], s44 offen offset:256 lds
    v_cndmask_b32 v192, v22, 0, s[100:101]
    v_subrev_u32 v20, 1, v19
    v_and_b32 v21, 1, v20
    v_cmp_eq_u32 s[42:43], 0, v21
    v_cmp_le_i32 s[40:41], 0, v20
    v_cmp_ge_i32 s[100:101], -2, v20
    s_and_b64 s[40:41], s[40:41], s[42:43]
    s_and_b64 s[100:101], s[100:101], s[42:43]
    v_cndmask_b32 v197, v22, 0, s[40:41]
    v_cndmask_b32 v193, v22, 0, s[100:101]
    v_subrev_u32 v20, 2, v19
    v_and_b32 v21, 1, v20
    v_cmp_eq_u32 s[42:43], 0, v21
    v_cmp_le_i32 s[40:41], 0, v20
    v_cmp_ge_i32 s[100:101], -2, v20
    s_and_b64 s[40:41], s[40:41], s[42:43]
    s_and_b64 s[100:101], s[100:101], s[42:43]
    v_cndmask_b32 v198, v22, 0, s[40:41]
    v_cndmask_b32 v194, v22, 0, s[100:101]
    v_subrev_u32 v20, 3, v19
    v_and_b32 v21, 1, v20
    v_cmp_eq_u32 s[42:43], 0, v21
    v_cmp_le_i32 s[40:41], 0, v20
    v_cmp_ge_i32 s[100:101], -2, v20
    s_and_b64 s[40:41], s[40:41], s[42:43]
    s_and_b64 s[100:101], s[100:101], s[42:43]
    v_cndmask_b32 v199, v22, 0, s[40:41]
    s_add_u32 m0, s48, 31488
    s_nop 0
    buffer_load_dwordx4 v2, s[4:7], s45 offen offset:256 lds
    v_cndmask_b32 v195, v22, 0, s[100:101]
    s_or_b32 s40, s32, s34
    s_cmp_eq_u32 s40, 0
    s_cselect_b64 s[42:43], -1, 0
    v_cndmask_b32 v200, v192, v22, s[42:43]
    v_cndmask_b32 v201, v193, v22, s[42:43]
    v_cndmask_b32 v202, v194, v22, s[42:43]
    v_cndmask_b32 v203, v195, v22, s[42:43]
    s_add_u32 m0, s48, 32512
    s_nop 0
    buffer_load_dwordx4 v1, s[4:7], s46 offen offset:256 lds
    s_add_u32 m0, s48, 33536
    s_nop 0
    buffer_load_dwordx4 v2, s[4:7], s47 offen offset:256 lds
    s_mov_b32 s54, 344064
    s_add_u32 m0, s50, 30720
    s_nop 0
    buffer_load_dwordx4 v4, s[8:11], s54 offen offset:0 lds
    s_add_u32 m0, s50, 30848
    s_nop 0
    buffer_load_dwordx4 v4, s[8:11], s54 offen offset:896 lds
    s_add_u32 m0, s50, 30976
    s_nop 0
    buffer_load_dwordx4 v4, s[8:11], s54 offen offset:1792 lds
    s_mov_b32 s55, 256
    s_add_u32 m0, s49, 30720
    s_mov_b64 exec, s[52:53]
    buffer_load_dwordx4 v3, s[4:7], s55 offen lds
    s_mov_b64 exec, -1
    s_waitcnt lgkmcnt(0)
    s_barrier
    ds_read_b128 v[88:91], v5 offset:61440
    ds_read_b64_tr_b16 v[100:101], v13 offset:0
    ds_read_b64_tr_b16 v[102:103], v13 offset:3072
    ds_read_b128 v[92:95], v5 offset:63488
    ds_read_b64_tr_b16 v[104:105], v14 offset:0
    ds_read_b64_tr_b16 v[106:107], v14 offset:3072
    ds_read_b64_tr_b16 v[108:109], v13 offset:1024
    ds_read_b64_tr_b16 v[110:111], v13 offset:4096
    ds_read_b64_tr_b16 v[112:113], v14 offset:1024
    ds_read_b64_tr_b16 v[114:115], v14 offset:4096
    ds_read_b64_tr_b16 v[116:117], v13 offset:2048
    ds_read_b64_tr_b16 v[118:119], v13 offset:5120
    ds_read_b64_tr_b16 v[120:121], v14 offset:2048
    ds_read_b64_tr_b16 v[122:123], v14 offset:5120
    ds_read_b128 v[96:99], v7 offset:61440
    ds_read_b64_tr_b16 v[124:125], v15 offset:0
    ds_read_b64_tr_b16 v[126:127], v15 offset:3072
    ds_read_b64_tr_b16 v[128:129], v16 offset:0
    ds_read_b64_tr_b16 v[130:131], v16 offset:3072
    s_waitcnt lgkmcnt(15)
    v_mfma_f32_16x16x32_bf16 v[32:35], v[100:103], v[88:91], 0
    ds_read_b128 v[132:135], v6 offset:61440
    v_mfma_f32_16x16x32_bf16 v[40:43], v[100:103], v[92:95], 0
    ds_read_b64_tr_b16 v[144:145], v13 offset:6144
    s_waitcnt lgkmcnt(15)
    v_mfma_f32_16x16x32_bf16 v[36:39], v[104:107], v[88:91], 0
    ds_read_b64_tr_b16 v[146:147], v13 offset:9216
    ds_read_b128 v[136:139], v6 offset:63488
    v_mfma_f32_16x16x32_bf16 v[44:47], v[104:107], v[92:95], 0
    ds_read_b64_tr_b16 v[148:149], v14 offset:6144
    s_waitcnt lgkmcnt(15)
    v_mfma_f32_16x16x32_bf16 v[48:51], v[108:111], v[88:91], 0
    ds_read_b64_tr_b16 v[150:151], v14 offset:9216
    v_mfma_f32_16x16x32_bf16 v[56:59], v[108:111], v[92:95], 0
    ds_read_b64_tr_b16 v[152:153], v13 offset:7168
    ds_read_b64_tr_b16 v[154:155], v13 offset:10240
    s_waitcnt lgkmcnt(15)
    v_mfma_f32_16x16x32_bf16 v[52:55], v[112:115], v[88:91], 0
    ds_read_b64_tr_b16 v[156:157], v14 offset:7168
    v_mfma_f32_16x16x32_bf16 v[60:63], v[112:115], v[92:95], 0
    ds_read_b64_tr_b16 v[158:159], v14 offset:10240
    v_mfma_f32_16x16x32_bf16 v[64:67], v[116:119], v[88:91], 0
    ds_read_b64_tr_b16 v[160:161], v13 offset:8192
    ds_read_b64_tr_b16 v[162:163], v13 offset:11264
    v_mfma_f32_16x16x32_bf16 v[72:75], v[116:119], v[92:95], 0
    ds_read_b64_tr_b16 v[164:165], v14 offset:8192
    s_waitcnt lgkmcnt(15)
    v_mfma_f32_16x16x32_bf16 v[68:71], v[120:123], v[88:91], 0
    ds_read_b64_tr_b16 v[166:167], v14 offset:11264
    v_mfma_f32_16x16x32_bf16 v[76:79], v[120:123], v[92:95], 0
    ds_read_b128 v[140:143], v8 offset:61440
    ds_read_b64_tr_b16 v[168:169], v15 offset:6144
    v_mfma_f32_16x16x32_bf16 v[80:83], v[124:127], v[96:99], 0
    ds_read_b64_tr_b16 v[170:171], v15 offset:9216
    s_waitcnt lgkmcnt(15)
    v_mfma_f32_16x16x32_bf16 v[84:87], v[128:131], v[96:99], 0
    ds_read_b64_tr_b16 v[172:173], v16 offset:6144
    ds_read_b64_tr_b16 v[174:175], v16 offset:9216
    s_waitcnt lgkmcnt(15)
    v_mfma_f32_16x16x32_bf16 v[32:35], v[144:147], v[132:135], v[32:35]
    v_mfma_f32_16x16x32_bf16 v[40:43], v[144:147], v[136:139], v[40:43]
    s_waitcnt lgkmcnt(13)
    v_mfma_f32_16x16x32_bf16 v[36:39], v[148:151], v[132:135], v[36:39]
    s_waitcnt lgkmcnt(0)
    s_waitcnt vmcnt(9)
    s_barrier
    v_mfma_f32_16x16x32_bf16 v[44:47], v[148:151], v[136:139], v[44:47]
    ds_read_b128 v[88:91], v5 offset:0
    v_mfma_f32_16x16x32_bf16 v[48:51], v[152:155], v[132:135], v[48:51]
    ds_read_b64_tr_b16 v[100:101], v9 offset:0
    ds_read_b64_tr_b16 v[102:103], v9 offset:3072
    s_add_u32 m0, s48, 61056
    v_mfma_f32_16x16x32_bf16 v[56:59], v[152:155], v[136:139], v[56:59]
    ds_read_b128 v[92:95], v5 offset:2048
    ds_read_b64_tr_b16 v[104:105], v10 offset:0
    v_mfma_f32_16x16x32_bf16 v[52:55], v[156:159], v[132:135], v[52:55]
    ds_read_b64_tr_b16 v[106:107], v10 offset:3072
    buffer_load_dwordx4 v1, s[4:7], s44 offen offset:384 lds
    v_mfma_f32_16x16x32_bf16 v[60:63], v[156:159], v[136:139], v[60:63]
    ds_read_b64_tr_b16 v[108:109], v9 offset:1024
    ds_read_b64_tr_b16 v[110:111], v9 offset:4096
    s_add_u32 m0, s48, 62080
    v_mfma_f32_16x16x32_bf16 v[64:67], v[160:163], v[132:135], v[64:67]
    ds_read_b64_tr_b16 v[112:113], v10 offset:1024
    ds_read_b64_tr_b16 v[114:115], v10 offset:4096
    v_mfma_f32_16x16x32_bf16 v[72:75], v[160:163], v[136:139], v[72:75]
    ds_read_b64_tr_b16 v[116:117], v9 offset:2048
    ds_read_b64_tr_b16 v[118:119], v9 offset:5120
    buffer_load_dwordx4 v2, s[4:7], s45 offen offset:384 lds
    v_mfma_f32_16x16x32_bf16 v[68:71], v[164:167], v[132:135], v[68:71]
    ds_read_b64_tr_b16 v[120:121], v10 offset:2048
    s_add_u32 m0, s48, 63104
    v_mfma_f32_16x16x32_bf16 v[76:79], v[164:167], v[136:139], v[76:79]
    ds_read_b64_tr_b16 v[122:123], v10 offset:5120
    ds_read_b128 v[96:99], v7 offset:0
    v_mfma_f32_16x16x32_bf16 v[80:83], v[168:171], v[140:143], v[80:83]
    ds_read_b64_tr_b16 v[124:125], v11 offset:0
    ds_read_b64_tr_b16 v[126:127], v11 offset:3072
    buffer_load_dwordx4 v1, s[4:7], s46 offen offset:384 lds
    v_mfma_f32_16x16x32_bf16 v[84:87], v[172:175], v[140:143], v[84:87]
    ds_read_b64_tr_b16 v[128:129], v12 offset:0
    ds_read_b64_tr_b16 v[130:131], v12 offset:3072
    s_add_u32 m0, s48, 64128
    s_waitcnt lgkmcnt(15)
    v_mfma_f32_16x16x32_bf16 v[32:35], v[100:103], v[88:91], v[32:35]
    ds_read_b128 v[132:135], v6 offset:0
    v_mfma_f32_16x16x32_bf16 v[40:43], v[100:103], v[92:95], v[40:43]
    ds_read_b64_tr_b16 v[144:145], v9 offset:6144
    buffer_load_dwordx4 v2, s[4:7], s47 offen offset:384 lds
    s_waitcnt lgkmcnt(15)
    v_mfma_f32_16x16x32_bf16 v[36:39], v[104:107], v[88:91], v[36:39]
    ds_read_b64_tr_b16 v[146:147], v9 offset:9216
    ds_read_b128 v[136:139], v6 offset:2048
    s_mov_b32 s54, 516096
    v_mfma_f32_16x16x32_bf16 v[44:47], v[104:107], v[92:95], v[44:47]
    ds_read_b64_tr_b16 v[148:149], v10 offset:6144
    s_add_u32 m0, s50, 61440
    s_waitcnt lgkmcnt(15)
    v_mfma_f32_16x16x32_bf16 v[48:51], v[108:111], v[88:91], v[48:51]
    ds_read_b64_tr_b16 v[150:151], v10 offset:9216
    v_mfma_f32_16x16x32_bf16 v[56:59], v[108:111], v[92:95], v[56:59]
    ds_read_b64_tr_b16 v[152:153], v9 offset:7168
    ds_read_b64_tr_b16 v[154:155], v9 offset:10240
    buffer_load_dwordx4 v4, s[8:11], s54 offen offset:0 lds
    s_waitcnt lgkmcnt(15)
    v_mfma_f32_16x16x32_bf16 v[52:55], v[112:115], v[88:91], v[52:55]
    ds_read_b64_tr_b16 v[156:157], v10 offset:7168
    s_add_u32 m0, s50, 61568
    v_mfma_f32_16x16x32_bf16 v[60:63], v[112:115], v[92:95], v[60:63]
    ds_read_b64_tr_b16 v[158:159], v10 offset:10240
    buffer_load_dwordx4 v4, s[8:11], s54 offen offset:896 lds
    v_mfma_f32_16x16x32_bf16 v[64:67], v[116:119], v[88:91], v[64:67]
    ds_read_b64_tr_b16 v[160:161], v9 offset:8192
    ds_read_b64_tr_b16 v[162:163], v9 offset:11264
    s_add_u32 m0, s50, 61696
    v_mfma_f32_16x16x32_bf16 v[72:75], v[116:119], v[92:95], v[72:75]
    ds_read_b64_tr_b16 v[164:165], v10 offset:8192
    s_waitcnt lgkmcnt(15)
    v_mfma_f32_16x16x32_bf16 v[68:71], v[120:123], v[88:91], v[68:71]
    ds_read_b64_tr_b16 v[166:167], v10 offset:11264
    buffer_load_dwordx4 v4, s[8:11], s54 offen offset:1792 lds
    v_mfma_f32_16x16x32_bf16 v[76:79], v[120:123], v[92:95], v[76:79]
    ds_read_b128 v[140:143], v8 offset:0
    ds_read_b64_tr_b16 v[168:169], v11 offset:6144
    s_mov_b32 s55, 384
    v_mfma_f32_16x16x32_bf16 v[80:83], v[124:127], v[96:99], v[80:83]
    ds_read_b64_tr_b16 v[170:171], v11 offset:9216
    s_add_u32 m0, s49, 61440
    s_waitcnt lgkmcnt(15)
    v_mfma_f32_16x16x32_bf16 v[84:87], v[128:131], v[96:99], v[84:87]
    ds_read_b64_tr_b16 v[172:173], v12 offset:6144
    ds_read_b64_tr_b16 v[174:175], v12 offset:9216
    s_mov_b64 exec, s[52:53]
    buffer_load_dwordx4 v3, s[4:7], s55 offen lds
    s_mov_b64 exec, -1
    s_waitcnt lgkmcnt(15)
    v_mfma_f32_16x16x32_bf16 v[32:35], v[144:147], v[132:135], v[32:35]
    v_mfma_f32_16x16x32_bf16 v[40:43], v[144:147], v[136:139], v[40:43]
    s_waitcnt lgkmcnt(13)
    v_mfma_f32_16x16x32_bf16 v[36:39], v[148:151], v[132:135], v[36:39]
    s_waitcnt lgkmcnt(0)
    s_waitcnt vmcnt(8)
    s_barrier
    v_mfma_f32_16x16x32_bf16 v[44:47], v[148:151], v[136:139], v[44:47]
    ds_read_b128 v[88:91], v5 offset:30720
    v_mfma_f32_16x16x32_bf16 v[48:51], v[152:155], v[132:135], v[48:51]
    ds_read_b64_tr_b16 v[100:101], v9 offset:30720
    ds_read_b64_tr_b16 v[102:103], v9 offset:33792
    s_add_u32 m0, s48, -512
    v_mfma_f32_16x16x32_bf16 v[56:59], v[152:155], v[136:139], v[56:59]
    ds_read_b128 v[92:95], v5 offset:32768
    ds_read_b64_tr_b16 v[104:105], v10 offset:30720
    v_mfma_f32_16x16x32_bf16 v[52:55], v[156:159], v[132:135], v[52:55]
    ds_read_b64_tr_b16 v[106:107], v10 offset:33792
    buffer_load_dwordx4 v1, s[4:7], s44 offen offset:512 lds
    v_mfma_f32_16x16x32_bf16 v[60:63], v[156:159], v[136:139], v[60:63]
    ds_read_b64_tr_b16 v[108:109], v9 offset:31744
    ds_read_b64_tr_b16 v[110:111], v9 offset:34816
    s_add_u32 m0, s48, 512
    v_mfma_f32_16x16x32_bf16 v[64:67], v[160:163], v[132:135], v[64:67]
    ds_read_b64_tr_b16 v[112:113], v10 offset:31744
    ds_read_b64_tr_b16 v[114:115], v10 offset:34816
    v_mfma_f32_16x16x32_bf16 v[72:75], v[160:163], v[136:139], v[72:75]
    ds_read_b64_tr_b16 v[116:117], v9 offset:32768
    ds_read_b64_tr_b16 v[118:119], v9 offset:35840
    buffer_load_dwordx4 v2, s[4:7], s45 offen offset:512 lds
    v_mfma_f32_16x16x32_bf16 v[68:71], v[164:167], v[132:135], v[68:71]
    ds_read_b64_tr_b16 v[120:121], v10 offset:32768
    s_add_u32 m0, s48, 1536
    v_mfma_f32_16x16x32_bf16 v[76:79], v[164:167], v[136:139], v[76:79]
    ds_read_b64_tr_b16 v[122:123], v10 offset:35840
    ds_read_b128 v[96:99], v7 offset:30720
    v_mfma_f32_16x16x32_bf16 v[80:83], v[168:171], v[140:143], v[80:83]
    ds_read_b64_tr_b16 v[124:125], v11 offset:30720
    ds_read_b64_tr_b16 v[126:127], v11 offset:33792
    buffer_load_dwordx4 v1, s[4:7], s46 offen offset:512 lds
    v_mfma_f32_16x16x32_bf16 v[84:87], v[172:175], v[140:143], v[84:87]
    ds_read_b64_tr_b16 v[128:129], v12 offset:30720
    ds_read_b64_tr_b16 v[130:131], v12 offset:33792
    s_add_u32 m0, s48, 2560
    s_waitcnt lgkmcnt(15)
    v_mfma_f32_16x16x32_bf16 v[32:35], v[100:103], v[88:91], v[32:35]
    ds_read_b128 v[132:135], v6 offset:30720
    v_mfma_f32_16x16x32_bf16 v[40:43], v[100:103], v[92:95], v[40:43]
    ds_read_b64_tr_b16 v[144:145], v9 offset:36864
    buffer_load_dwordx4 v2, s[4:7], s47 offen offset:512 lds
    s_waitcnt lgkmcnt(15)
    v_mfma_f32_16x16x32_bf16 v[36:39], v[104:107], v[88:91], v[36:39]
    ds_read_b64_tr_b16 v[146:147], v9 offset:39936
    ds_read_b128 v[136:139], v6 offset:32768
    s_mov_b32 s54, 688128
    v_mfma_f32_16x16x32_bf16 v[44:47], v[104:107], v[92:95], v[44:47]
    ds_read_b64_tr_b16 v[148:149], v10 offset:36864
    s_add_u32 m0, s50, 0
    s_waitcnt lgkmcnt(15)
    v_mfma_f32_16x16x32_bf16 v[48:51], v[108:111], v[88:91], v[48:51]
    ds_read_b64_tr_b16 v[150:151], v10 offset:39936
    v_mfma_f32_16x16x32_bf16 v[56:59], v[108:111], v[92:95], v[56:59]
    ds_read_b64_tr_b16 v[152:153], v9 offset:37888
    ds_read_b64_tr_b16 v[154:155], v9 offset:40960
    buffer_load_dwordx4 v4, s[8:11], s54 offen offset:0 lds
    s_waitcnt lgkmcnt(15)
    v_mfma_f32_16x16x32_bf16 v[52:55], v[112:115], v[88:91], v[52:55]
    ds_read_b64_tr_b16 v[156:157], v10 offset:37888
    s_add_u32 m0, s50, 128
    v_mfma_f32_16x16x32_bf16 v[60:63], v[112:115], v[92:95], v[60:63]
    ds_read_b64_tr_b16 v[158:159], v10 offset:40960
    buffer_load_dwordx4 v4, s[8:11], s54 offen offset:896 lds
    v_mfma_f32_16x16x32_bf16 v[64:67], v[116:119], v[88:91], v[64:67]
    ds_read_b64_tr_b16 v[160:161], v9 offset:38912
    ds_read_b64_tr_b16 v[162:163], v9 offset:41984
    s_add_u32 m0, s50, 256
    v_mfma_f32_16x16x32_bf16 v[72:75], v[116:119], v[92:95], v[72:75]
    ds_read_b64_tr_b16 v[164:165], v10 offset:38912
    s_waitcnt lgkmcnt(15)
    v_mfma_f32_16x16x32_bf16 v[68:71], v[120:123], v[88:91], v[68:71]
    ds_read_b64_tr_b16 v[166:167], v10 offset:41984
    buffer_load_dwordx4 v4, s[8:11], s54 offen offset:1792 lds
    v_mfma_f32_16x16x32_bf16 v[76:79], v[120:123], v[92:95], v[76:79]
    ds_read_b128 v[140:143], v8 offset:30720
    ds_read_b64_tr_b16 v[168:169], v11 offset:36864
    s_mov_b32 s55, 512
    v_mfma_f32_16x16x32_bf16 v[80:83], v[124:127], v[96:99], v[80:83]
    ds_read_b64_tr_b16 v[170:171], v11 offset:39936
    s_add_u32 m0, s49, 0
    s_waitcnt lgkmcnt(15)
    v_mfma_f32_16x16x32_bf16 v[84:87], v[128:131], v[96:99], v[84:87]
    ds_read_b64_tr_b16 v[172:173], v12 offset:36864
    ds_read_b64_tr_b16 v[174:175], v12 offset:39936
    s_mov_b64 exec, s[52:53]
    buffer_load_dwordx4 v3, s[4:7], s55 offen lds
    s_mov_b64 exec, -1
    s_waitcnt lgkmcnt(15)
    v_mfma_f32_16x16x32_bf16 v[32:35], v[144:147], v[132:135], v[32:35]
    v_mfma_f32_16x16x32_bf16 v[40:43], v[144:147], v[136:139], v[40:43]
    s_waitcnt lgkmcnt(13)
    v_mfma_f32_16x16x32_bf16 v[36:39], v[148:151], v[132:135], v[36:39]
    s_waitcnt lgkmcnt(0)
    s_waitcnt vmcnt(8)
    s_barrier
    v_mfma_f32_16x16x32_bf16 v[44:47], v[148:151], v[136:139], v[44:47]
    ds_read_b128 v[88:91], v5 offset:61440
    v_mfma_f32_16x16x32_bf16 v[48:51], v[152:155], v[132:135], v[48:51]
    ds_read_b64_tr_b16 v[100:101], v13 offset:0
    ds_read_b64_tr_b16 v[102:103], v13 offset:3072
    s_add_u32 m0, s48, 30080
    v_mfma_f32_16x16x32_bf16 v[56:59], v[152:155], v[136:139], v[56:59]
    ds_read_b128 v[92:95], v5 offset:63488
    ds_read_b64_tr_b16 v[104:105], v14 offset:0
    v_mfma_f32_16x16x32_bf16 v[52:55], v[156:159], v[132:135], v[52:55]
    ds_read_b64_tr_b16 v[106:107], v14 offset:3072
    buffer_load_dwordx4 v1, s[4:7], s44 offen offset:640 lds
    v_mfma_f32_16x16x32_bf16 v[60:63], v[156:159], v[136:139], v[60:63]
    ds_read_b64_tr_b16 v[108:109], v13 offset:1024
    ds_read_b64_tr_b16 v[110:111], v13 offset:4096
    s_add_u32 m0, s48, 31104
    v_mfma_f32_16x16x32_bf16 v[64:67], v[160:163], v[132:135], v[64:67]
    ds_read_b64_tr_b16 v[112:113], v14 offset:1024
    ds_read_b64_tr_b16 v[114:115], v14 offset:4096
    v_mfma_f32_16x16x32_bf16 v[72:75], v[160:163], v[136:139], v[72:75]
    ds_read_b64_tr_b16 v[116:117], v13 offset:2048
    ds_read_b64_tr_b16 v[118:119], v13 offset:5120
    buffer_load_dwordx4 v2, s[4:7], s45 offen offset:640 lds
    v_mfma_f32_16x16x32_bf16 v[68:71], v[164:167], v[132:135], v[68:71]
    ds_read_b64_tr_b16 v[120:121], v14 offset:2048
    s_add_u32 m0, s48, 32128
    v_mfma_f32_16x16x32_bf16 v[76:79], v[164:167], v[136:139], v[76:79]
    ds_read_b64_tr_b16 v[122:123], v14 offset:5120
    ds_read_b128 v[96:99], v7 offset:61440
    v_mfma_f32_16x16x32_bf16 v[80:83], v[168:171], v[140:143], v[80:83]
    ds_read_b64_tr_b16 v[124:125], v15 offset:0
    ds_read_b64_tr_b16 v[126:127], v15 offset:3072
    buffer_load_dwordx4 v1, s[4:7], s46 offen offset:640 lds
    v_mfma_f32_16x16x32_bf16 v[84:87], v[172:175], v[140:143], v[84:87]
    ds_read_b64_tr_b16 v[128:129], v16 offset:0
    ds_read_b64_tr_b16 v[130:131], v16 offset:3072
    s_add_u32 m0, s48, 33152
    s_waitcnt lgkmcnt(15)
    v_mfma_f32_16x16x32_bf16 v[32:35], v[100:103], v[88:91], v[32:35]
    ds_read_b128 v[132:135], v6 offset:61440
    v_mfma_f32_16x16x32_bf16 v[40:43], v[100:103], v[92:95], v[40:43]
    ds_read_b64_tr_b16 v[144:145], v13 offset:6144
    buffer_load_dwordx4 v2, s[4:7], s47 offen offset:640 lds
    s_waitcnt lgkmcnt(15)
    v_mfma_f32_16x16x32_bf16 v[36:39], v[104:107], v[88:91], v[36:39]
    ds_read_b64_tr_b16 v[146:147], v13 offset:9216
    ds_read_b128 v[136:139], v6 offset:63488
    s_mov_b32 s54, 860160
    v_mfma_f32_16x16x32_bf16 v[44:47], v[104:107], v[92:95], v[44:47]
    ds_read_b64_tr_b16 v[148:149], v14 offset:6144
    s_add_u32 m0, s50, 30720
    s_waitcnt lgkmcnt(15)
    v_mfma_f32_16x16x32_bf16 v[48:51], v[108:111], v[88:91], v[48:51]
    ds_read_b64_tr_b16 v[150:151], v14 offset:9216
    v_mfma_f32_16x16x32_bf16 v[56:59], v[108:111], v[92:95], v[56:59]
    ds_read_b64_tr_b16 v[152:153], v13 offset:7168
    ds_read_b64_tr_b16 v[154:155], v13 offset:10240
    buffer_load_dwordx4 v4, s[8:11], s54 offen offset:0 lds
    s_waitcnt lgkmcnt(15)
    v_mfma_f32_16x16x32_bf16 v[52:55], v[112:115], v[88:91], v[52:55]
    ds_read_b64_tr_b16 v[156:157], v14 offset:7168
    s_add_u32 m0, s50, 30848
    v_mfma_f32_16x16x32_bf16 v[60:63], v[112:115], v[92:95], v[60:63]
    ds_read_b64_tr_b16 v[158:159], v14 offset:10240
    buffer_load_dwordx4 v4, s[8:11], s54 offen offset:896 lds
    v_mfma_f32_16x16x32_bf16 v[64:67], v[116:119], v[88:91], v[64:67]
    ds_read_b64_tr_b16 v[160:161], v13 offset:8192
    ds_read_b64_tr_b16 v[162:163], v13 offset:11264
    s_add_u32 m0, s50, 30976
    v_mfma_f32_16x16x32_bf16 v[72:75], v[116:119], v[92:95], v[72:75]
    ds_read_b64_tr_b16 v[164:165], v14 offset:8192
    s_waitcnt lgkmcnt(15)
    v_mfma_f32_16x16x32_bf16 v[68:71], v[120:123], v[88:91], v[68:71]
    ds_read_b64_tr_b16 v[166:167], v14 offset:11264
    buffer_load_dwordx4 v4, s[8:11], s54 offen offset:1792 lds
    v_mfma_f32_16x16x32_bf16 v[76:79], v[120:123], v[92:95], v[76:79]
    ds_read_b128 v[140:143], v8 offset:61440
    ds_read_b64_tr_b16 v[168:169], v15 offset:6144
    s_mov_b32 s55, 640
    v_mfma_f32_16x16x32_bf16 v[80:83], v[124:127], v[96:99], v[80:83]
    ds_read_b64_tr_b16 v[170:171], v15 offset:9216
    s_add_u32 m0, s49, 30720
    s_waitcnt lgkmcnt(15)
    v_mfma_f32_16x16x32_bf16 v[84:87], v[128:131], v[96:99], v[84:87]
    ds_read_b64_tr_b16 v[172:173], v16 offset:6144
    ds_read_b64_tr_b16 v[174:175], v16 offset:9216
    s_mov_b64 exec, s[52:53]
    buffer_load_dwordx4 v3, s[4:7], s55 offen lds
    s_mov_b64 exec, -1
    s_waitcnt lgkmcnt(15)
    v_mfma_f32_16x16x32_bf16 v[32:35], v[144:147], v[132:135], v[32:35]
    v_mfma_f32_16x16x32_bf16 v[40:43], v[144:147], v[136:139], v[40:43]
    s_waitcnt lgkmcnt(13)
    v_mfma_f32_16x16x32_bf16 v[36:39], v[148:151], v[132:135], v[36:39]
    s_waitcnt lgkmcnt(0)
    s_waitcnt vmcnt(8)
    s_barrier
    v_mfma_f32_16x16x32_bf16 v[44:47], v[148:151], v[136:139], v[44:47]
    ds_read_b128 v[88:91], v5 offset:0
    v_mfma_f32_16x16x32_bf16 v[48:51], v[152:155], v[132:135], v[48:51]
    ds_read_b64_tr_b16 v[100:101], v9 offset:0
    ds_read_b64_tr_b16 v[102:103], v9 offset:3072
    s_add_u32 m0, s48, 60672
    v_mfma_f32_16x16x32_bf16 v[56:59], v[152:155], v[136:139], v[56:59]
    ds_read_b128 v[92:95], v5 offset:2048
    ds_read_b64_tr_b16 v[104:105], v10 offset:0
    v_mfma_f32_16x16x32_bf16 v[52:55], v[156:159], v[132:135], v[52:55]
    ds_read_b64_tr_b16 v[106:107], v10 offset:3072
    buffer_load_dwordx4 v1, s[4:7], s44 offen offset:768 lds
    v_mfma_f32_16x16x32_bf16 v[60:63], v[156:159], v[136:139], v[60:63]
    ds_read_b64_tr_b16 v[108:109], v9 offset:1024
    ds_read_b64_tr_b16 v[110:111], v9 offset:4096
    s_add_u32 m0, s48, 61696
    v_mfma_f32_16x16x32_bf16 v[64:67], v[160:163], v[132:135], v[64:67]
    ds_read_b64_tr_b16 v[112:113], v10 offset:1024
    ds_read_b64_tr_b16 v[114:115], v10 offset:4096
    v_mfma_f32_16x16x32_bf16 v[72:75], v[160:163], v[136:139], v[72:75]
    ds_read_b64_tr_b16 v[116:117], v9 offset:2048
    ds_read_b64_tr_b16 v[118:119], v9 offset:5120
    buffer_load_dwordx4 v2, s[4:7], s45 offen offset:768 lds
    v_mfma_f32_16x16x32_bf16 v[68:71], v[164:167], v[132:135], v[68:71]
    ds_read_b64_tr_b16 v[120:121], v10 offset:2048
    s_add_u32 m0, s48, 62720
    v_mfma_f32_16x16x32_bf16 v[76:79], v[164:167], v[136:139], v[76:79]
    ds_read_b64_tr_b16 v[122:123], v10 offset:5120
    ds_read_b128 v[96:99], v7 offset:0
    v_mfma_f32_16x16x32_bf16 v[80:83], v[168:171], v[140:143], v[80:83]
    ds_read_b64_tr_b16 v[124:125], v11 offset:0
    ds_read_b64_tr_b16 v[126:127], v11 offset:3072
    buffer_load_dwordx4 v1, s[4:7], s46 offen offset:768 lds
    v_mfma_f32_16x16x32_bf16 v[84:87], v[172:175], v[140:143], v[84:87]
    ds_read_b64_tr_b16 v[128:129], v12 offset:0
    ds_read_b64_tr_b16 v[130:131], v12 offset:3072
    s_add_u32 m0, s48, 63744
    s_waitcnt lgkmcnt(15)
    v_mfma_f32_16x16x32_bf16 v[32:35], v[100:103], v[88:91], v[32:35]
    ds_read_b128 v[132:135], v6 offset:0
    v_mfma_f32_16x16x32_bf16 v[40:43], v[100:103], v[92:95], v[40:43]
    ds_read_b64_tr_b16 v[144:145], v9 offset:6144
    buffer_load_dwordx4 v2, s[4:7], s47 offen offset:768 lds
    s_waitcnt lgkmcnt(15)
    v_mfma_f32_16x16x32_bf16 v[36:39], v[104:107], v[88:91], v[36:39]
    ds_read_b64_tr_b16 v[146:147], v9 offset:9216
    ds_read_b128 v[136:139], v6 offset:2048
    s_mov_b32 s54, 1032192
    v_mfma_f32_16x16x32_bf16 v[44:47], v[104:107], v[92:95], v[44:47]
    ds_read_b64_tr_b16 v[148:149], v10 offset:6144
    s_add_u32 m0, s50, 61440
    s_waitcnt lgkmcnt(15)
    v_mfma_f32_16x16x32_bf16 v[48:51], v[108:111], v[88:91], v[48:51]
    ds_read_b64_tr_b16 v[150:151], v10 offset:9216
    v_mfma_f32_16x16x32_bf16 v[56:59], v[108:111], v[92:95], v[56:59]
    ds_read_b64_tr_b16 v[152:153], v9 offset:7168
    ds_read_b64_tr_b16 v[154:155], v9 offset:10240
    buffer_load_dwordx4 v4, s[8:11], s54 offen offset:0 lds
    s_waitcnt lgkmcnt(15)
    v_mfma_f32_16x16x32_bf16 v[52:55], v[112:115], v[88:91], v[52:55]
    ds_read_b64_tr_b16 v[156:157], v10 offset:7168
    s_add_u32 m0, s50, 61568
    v_mfma_f32_16x16x32_bf16 v[60:63], v[112:115], v[92:95], v[60:63]
    ds_read_b64_tr_b16 v[158:159], v10 offset:10240
    buffer_load_dwordx4 v4, s[8:11], s54 offen offset:896 lds
    v_mfma_f32_16x16x32_bf16 v[64:67], v[116:119], v[88:91], v[64:67]
    ds_read_b64_tr_b16 v[160:161], v9 offset:8192
    ds_read_b64_tr_b16 v[162:163], v9 offset:11264
    s_add_u32 m0, s50, 61696
    v_mfma_f32_16x16x32_bf16 v[72:75], v[116:119], v[92:95], v[72:75]
    ds_read_b64_tr_b16 v[164:165], v10 offset:8192
    s_waitcnt lgkmcnt(15)
    v_mfma_f32_16x16x32_bf16 v[68:71], v[120:123], v[88:91], v[68:71]
    ds_read_b64_tr_b16 v[166:167], v10 offset:11264
    buffer_load_dwordx4 v4, s[8:11], s54 offen offset:1792 lds
    v_mfma_f32_16x16x32_bf16 v[76:79], v[120:123], v[92:95], v[76:79]
    ds_read_b128 v[140:143], v8 offset:0
    ds_read_b64_tr_b16 v[168:169], v11 offset:6144
    s_mov_b32 s55, 768
    v_mfma_f32_16x16x32_bf16 v[80:83], v[124:127], v[96:99], v[80:83]
    ds_read_b64_tr_b16 v[170:171], v11 offset:9216
    s_add_u32 m0, s49, 61440
    s_waitcnt lgkmcnt(15)
    v_mfma_f32_16x16x32_bf16 v[84:87], v[128:131], v[96:99], v[84:87]
    ds_read_b64_tr_b16 v[172:173], v12 offset:6144
    ds_read_b64_tr_b16 v[174:175], v12 offset:9216
    s_mov_b64 exec, s[52:53]
    buffer_load_dwordx4 v3, s[4:7], s55 offen lds
    s_mov_b64 exec, -1
    s_waitcnt lgkmcnt(15)
    v_mfma_f32_16x16x32_bf16 v[32:35], v[144:147], v[132:135], v[32:35]
    v_mfma_f32_16x16x32_bf16 v[40:43], v[144:147], v[136:139], v[40:43]
    s_waitcnt lgkmcnt(13)
    v_mfma_f32_16x16x32_bf16 v[36:39], v[148:151], v[132:135], v[36:39]
    s_waitcnt lgkmcnt(0)
    s_waitcnt vmcnt(8)
    s_barrier
    v_mfma_f32_16x16x32_bf16 v[44:47], v[148:151], v[136:139], v[44:47]
    ds_read_b128 v[88:91], v5 offset:30720
    s_lshl_b32 s68, s34, 9
    v_mfma_f32_16x16x32_bf16 v[48:51], v[152:155], v[132:135], v[48:51]
    ds_read_b64_tr_b16 v[100:101], v9 offset:30720
    ds_read_b64_tr_b16 v[102:103], v9 offset:33792
    s_add_u32 s68, s68, 256
    v_mfma_f32_16x16x32_bf16 v[56:59], v[152:155], v[136:139], v[56:59]
    ds_read_b128 v[92:95], v5 offset:32768
    ds_read_b64_tr_b16 v[104:105], v10 offset:30720
    v_lshl_add_u32 v212, v17, 7, v23
    v_mfma_f32_16x16x32_bf16 v[52:55], v[156:159], v[132:135], v[52:55]
    ds_read_b64_tr_b16 v[106:107], v10 offset:33792
    buffer_load_dwordx4 v[176:179], v23, s[28:31], s68 offen sc1
    v_mfma_f32_16x16x32_bf16 v[60:63], v[156:159], v[136:139], v[60:63]
    ds_read_b64_tr_b16 v[108:109], v9 offset:31744
    ds_read_b64_tr_b16 v[110:111], v9 offset:34816
    buffer_load_dwordx4 v[180:183], v23, s[28:31], s68 offen offset:256 sc1
    v_mfma_f32_16x16x32_bf16 v[64:67], v[160:163], v[132:135], v[64:67]
    ds_read_b64_tr_b16 v[112:113], v10 offset:31744
    ds_read_b64_tr_b16 v[114:115], v10 offset:34816
    buffer_load_dwordx4 v[184:187], v23, s[28:31], 0 offen sc1
    buffer_load_dwordx4 v[188:191], v212, s[28:31], 0 offen sc1
    v_mfma_f32_16x16x32_bf16 v[72:75], v[160:163], v[136:139], v[72:75]
    ds_read_b64_tr_b16 v[116:117], v9 offset:32768
    ds_read_b64_tr_b16 v[118:119], v9 offset:35840
    s_lshl_b32 s68, 1, s33
    v_mfma_f32_16x16x32_bf16 v[68:71], v[164:167], v[132:135], v[68:71]
    ds_read_b64_tr_b16 v[120:121], v10 offset:32768
    s_sub_u32 s68, s68, 1
    v_mfma_f32_16x16x32_bf16 v[76:79], v[164:167], v[136:139], v[76:79]
    ds_read_b64_tr_b16 v[122:123], v10 offset:35840
    ds_read_b128 v[96:99], v7 offset:30720
    s_and_b32 s68, s68, 0x55ab
    v_mfma_f32_16x16x32_bf16 v[80:83], v[168:171], v[140:143], v[80:83]
    ds_read_b64_tr_b16 v[124:125], v11 offset:30720
    ds_read_b64_tr_b16 v[126:127], v11 offset:33792
    s_bcnt1_i32_b32 s68, s68
    v_mfma_f32_16x16x32_bf16 v[84:87], v[172:175], v[140:143], v[84:87]
    ds_read_b64_tr_b16 v[128:129], v12 offset:30720
    ds_read_b64_tr_b16 v[130:131], v12 offset:33792
    s_mul_i32 s69, s32, 9
    s_add_u32 s68, s68, s69
    s_waitcnt lgkmcnt(15)
    v_mfma_f32_16x16x32_bf16 v[32:35], v[100:103], v[88:91], v[32:35]
    ds_read_b128 v[132:135], v6 offset:30720
    s_lshl_b32 s68, s68, 2
    v_mfma_f32_16x16x32_bf16 v[40:43], v[100:103], v[92:95], v[40:43]
    ds_read_b64_tr_b16 v[144:145], v9 offset:36864
    s_add_u32 s68, s68, s34
    s_waitcnt lgkmcnt(15)
    v_mfma_f32_16x16x32_bf16 v[36:39], v[104:107], v[88:91], v[36:39]
    ds_read_b64_tr_b16 v[146:147], v9 offset:39936
    ds_read_b128 v[136:139], v6 offset:32768
    s_lshr_b32 s69, 0x55ab, s33
    v_mfma_f32_16x16x32_bf16 v[44:47], v[104:107], v[92:95], v[44:47]
    ds_read_b64_tr_b16 v[148:149], v10 offset:36864
    s_and_b32 s69, s69, 1
    s_waitcnt lgkmcnt(15)
    v_mfma_f32_16x16x32_bf16 v[48:51], v[108:111], v[88:91], v[48:51]
    ds_read_b64_tr_b16 v[150:151], v10 offset:39936
    s_xor_b32 s69, s69, 1
    s_lshl_b32 s69, s69, 31
    v_mfma_f32_16x16x32_bf16 v[56:59], v[108:111], v[92:95], v[56:59]
    ds_read_b64_tr_b16 v[152:153], v9 offset:37888
    ds_read_b64_tr_b16 v[154:155], v9 offset:40960
    s_mul_i32 s40, s68, 22
    s_waitcnt lgkmcnt(15)
    v_mfma_f32_16x16x32_bf16 v[52:55], v[112:115], v[88:91], v[52:55]
    ds_read_b64_tr_b16 v[156:157], v10 offset:37888
    v_add_u32 v206, s40, v0
    v_mfma_f32_16x16x32_bf16 v[60:63], v[112:115], v[92:95], v[60:63]
    ds_read_b64_tr_b16 v[158:159], v10 offset:40960
    v_lshlrev_b32 v206, 7, v206
    v_mfma_f32_16x16x32_bf16 v[64:67], v[116:119], v[88:91], v[64:67]
    ds_read_b64_tr_b16 v[160:161], v9 offset:38912
    ds_read_b64_tr_b16 v[162:163], v9 offset:41984
    v_add_u32 v206, s69, v206
    v_mfma_f32_16x16x32_bf16 v[72:75], v[116:119], v[92:95], v[72:75]
    ds_read_b64_tr_b16 v[164:165], v10 offset:38912
    s_mul_i32 s40, s68, 6
    v_add_u32 v208, s40, v0
    s_waitcnt lgkmcnt(15)
    v_mfma_f32_16x16x32_bf16 v[68:71], v[120:123], v[88:91], v[68:71]
    ds_read_b64_tr_b16 v[166:167], v10 offset:41984
    v_lshlrev_b32 v208, 7, v208
    v_mfma_f32_16x16x32_bf16 v[76:79], v[120:123], v[92:95], v[76:79]
    ds_read_b128 v[140:143], v8 offset:30720
    ds_read_b64_tr_b16 v[168:169], v11 offset:36864
    v_add_u32 v208, s69, v208
    v_mfma_f32_16x16x32_bf16 v[80:83], v[124:127], v[96:99], v[80:83]
    ds_read_b64_tr_b16 v[170:171], v11 offset:39936
    s_mov_b64 exec, 0x3f
    buffer_load_dword a242, v208, s[12:15], 0 offen
    s_mov_b64 exec, -1
    s_waitcnt lgkmcnt(15)
    v_mfma_f32_16x16x32_bf16 v[84:87], v[128:131], v[96:99], v[84:87]
    ds_read_b64_tr_b16 v[172:173], v12 offset:36864
    ds_read_b64_tr_b16 v[174:175], v12 offset:39936
    s_mov_b64 exec, 0x3fffff
    buffer_load_dword a243, v206, s[16:19], 0 offen
    s_mov_b64 exec, -1
    s_mov_b64 exec, 0x3fffff
    buffer_load_dword a244, v206, s[20:23], 0 offen
    s_mov_b64 exec, -1
    s_waitcnt lgkmcnt(15)
    v_mfma_f32_16x16x32_bf16 v[32:35], v[144:147], v[132:135], v[32:35]
    v_mfma_f32_16x16x32_bf16 v[40:43], v[144:147], v[136:139], v[40:43]
    s_waitcnt lgkmcnt(13)
    v_mfma_f32_16x16x32_bf16 v[36:39], v[148:151], v[132:135], v[36:39]
    s_waitcnt lgkmcnt(0)
    s_waitcnt vmcnt(7)
    s_barrier
    v_mfma_f32_16x16x32_bf16 v[44:47], v[148:151], v[136:139], v[44:47]
    ds_read_b128 v[88:91], v5 offset:61440
    v_mfma_f32_16x16x32_bf16 v[48:51], v[152:155], v[132:135], v[48:51]
    ds_read_b64_tr_b16 v[100:101], v13 offset:0
    ds_read_b64_tr_b16 v[102:103], v13 offset:3072
    v_mfma_f32_16x16x32_bf16 v[56:59], v[152:155], v[136:139], v[56:59]
    ds_read_b128 v[92:95], v5 offset:63488
    ds_read_b64_tr_b16 v[104:105], v14 offset:0
    v_mfma_f32_16x16x32_bf16 v[52:55], v[156:159], v[132:135], v[52:55]
    ds_read_b64_tr_b16 v[106:107], v14 offset:3072
    v_mfma_f32_16x16x32_bf16 v[60:63], v[156:159], v[136:139], v[60:63]
    ds_read_b64_tr_b16 v[108:109], v13 offset:1024
    ds_read_b64_tr_b16 v[110:111], v13 offset:4096
    v_mfma_f32_16x16x32_bf16 v[64:67], v[160:163], v[132:135], v[64:67]
    ds_read_b64_tr_b16 v[112:113], v14 offset:1024
    ds_read_b64_tr_b16 v[114:115], v14 offset:4096
    v_mfma_f32_16x16x32_bf16 v[72:75], v[160:163], v[136:139], v[72:75]
    ds_read_b64_tr_b16 v[116:117], v13 offset:2048
    ds_read_b64_tr_b16 v[118:119], v13 offset:5120
    v_mfma_f32_16x16x32_bf16 v[68:71], v[164:167], v[132:135], v[68:71]
    ds_read_b64_tr_b16 v[120:121], v14 offset:2048
    v_mfma_f32_16x16x32_bf16 v[76:79], v[164:167], v[136:139], v[76:79]
    ds_read_b64_tr_b16 v[122:123], v14 offset:5120
    ds_read_b128 v[96:99], v7 offset:61440
    v_mfma_f32_16x16x32_bf16 v[80:83], v[168:171], v[140:143], v[80:83]
    ds_read_b64_tr_b16 v[124:125], v15 offset:0
    ds_read_b64_tr_b16 v[126:127], v15 offset:3072
    v_mfma_f32_16x16x32_bf16 v[84:87], v[172:175], v[140:143], v[84:87]
    ds_read_b64_tr_b16 v[128:129], v16 offset:0
    ds_read_b64_tr_b16 v[130:131], v16 offset:3072
    s_waitcnt lgkmcnt(15)
    v_mfma_f32_16x16x32_bf16 v[32:35], v[100:103], v[88:91], v[32:35]
    v_mfma_f32_16x16x32_bf16 v[40:43], v[100:103], v[92:95], v[40:43]
    s_mov_b32 s48, 0
L_gr_chk:
    s_waitcnt vmcnt(3)
    v_cmp_eq_u32 s[44:45], s35, v178
    v_cmp_eq_u32 s[42:43], s35, v182
    v_cmp_eq_u32 s[46:47], s35, v186
    v_cmp_eq_u32 vcc, s35, v190
    s_and_b64 s[44:45], s[44:45], s[42:43]
    s_and_b64 vcc, vcc, s[46:47]
    s_and_b64 vcc, vcc, s[44:45]
    s_cmp_eq_u64 vcc, -1
    s_cbranch_scc1 L_gr_ok
    s_add_u32 s48, s48, 1
    s_cmp_ge_u32 s48, 0x40000
    s_cbranch_scc1 L_gr_ok
    s_lshl_b32 s68, s34, 9
    s_add_u32 s68, s68, 256
    v_lshl_add_u32 v212, v17, 7, v23
    buffer_load_dwordx4 v[176:179], v23, s[28:31], s68 offen sc1
    buffer_load_dwordx4 v[180:183], v23, s[28:31], s68 offen offset:256 sc1
    buffer_load_dwordx4 v[184:187], v23, s[28:31], 0 offen sc1
    buffer_load_dwordx4 v[188:191], v212, s[28:31], 0 offen sc1
    s_waitcnt vmcnt(0)
    s_branch L_gr_chk
L_gr_ok:
    v_cmp_eq_u32 vcc, s36, v191
    s_nop 0
    s_cmp_eq_u64 vcc, -1
    s_cselect_b32 s37, 1, 0
    s_waitcnt lgkmcnt(13)
    v_mfma_f32_16x16x32_bf16 v[36:39], v[104:107], v[88:91], v[36:39]
    ds_read_b128 v[132:135], v6 offset:61440
    v_mfma_f32_16x16x32_bf16 v[44:47], v[104:107], v[92:95], v[44:47]
    ds_read_b64_tr_b16 v[144:145], v13 offset:6144
    ds_read_b64_tr_b16 v[146:147], v13 offset:9216
    s_waitcnt lgkmcnt(14)
    v_mfma_f32_16x16x32_bf16 v[48:51], v[108:111], v[88:91], v[48:51]
    ds_read_b128 v[136:139], v6 offset:63488
    v_mfma_f32_16x16x32_bf16 v[56:59], v[108:111], v[92:95], v[56:59]
    ds_read_b64_tr_b16 v[148:149], v14 offset:6144
    ds_read_b64_tr_b16 v[150:151], v14 offset:9216
    s_waitcnt lgkmcnt(15)
    v_mfma_f32_16x16x32_bf16 v[52:55], v[112:115], v[88:91], v[52:55]
    ds_read_b64_tr_b16 v[152:153], v13 offset:7168
    v_mfma_f32_16x16x32_bf16 v[60:63], v[112:115], v[92:95], v[60:63]
    ds_read_b64_tr_b16 v[154:155], v13 offset:10240
    ds_read_b64_tr_b16 v[156:157], v14 offset:7168
    s_waitcnt lgkmcnt(15)
    v_mfma_f32_16x16x32_bf16 v[64:67], v[116:119], v[88:91], v[64:67]
    ds_read_b64_tr_b16 v[158:159], v14 offset:10240
    ds_read_b64_tr_b16 v[160:161], v13 offset:8192
    v_mfma_f32_16x16x32_bf16 v[72:75], v[116:119], v[92:95], v[72:75]
    ds_read_b64_tr_b16 v[162:163], v13 offset:11264
    s_waitcnt lgkmcnt(15)
    v_mfma_f32_16x16x32_bf16 v[68:71], v[120:123], v[88:91], v[68:71]
    ds_read_b64_tr_b16 v[164:165], v14 offset:8192
    ds_read_b64_tr_b16 v[166:167], v14 offset:11264
    v_mfma_f32_16x16x32_bf16 v[76:79], v[120:123], v[92:95], v[76:79]
    ds_read_b128 v[140:143], v8 offset:61440
    s_waitcnt lgkmcnt(15)
    v_mfma_f32_16x16x32_bf16 v[80:83], v[124:127], v[96:99], v[80:83]
    ds_read_b64_tr_b16 v[168:169], v15 offset:6144
    ds_read_b64_tr_b16 v[170:171], v15 offset:9216
    v_mfma_f32_16x16x32_bf16 v[84:87], v[128:131], v[96:99], v[84:87]
    ds_read_b64_tr_b16 v[172:173], v16 offset:6144
    ds_read_b64_tr_b16 v[174:175], v16 offset:9216
    s_waitcnt lgkmcnt(15)
    v_mfma_f32_16x16x32_bf16 v[32:35], v[144:147], v[132:135], v[32:35]
    v_mfma_f32_16x16x32_bf16 v[40:43], v[144:147], v[136:139], v[40:43]
    s_waitcnt lgkmcnt(13)
    v_mfma_f32_16x16x32_bf16 v[36:39], v[148:151], v[132:135], v[36:39]
    v_mfma_f32_16x16x32_bf16 v[44:47], v[148:151], v[136:139], v[44:47]
    s_waitcnt lgkmcnt(11)
    v_mfma_f32_16x16x32_bf16 v[48:51], v[152:155], v[132:135], v[48:51]
    v_mfma_f32_16x16x32_bf16 v[56:59], v[152:155], v[136:139], v[56:59]
    s_waitcnt lgkmcnt(9)
    v_mfma_f32_16x16x32_bf16 v[52:55], v[156:159], v[132:135], v[52:55]
    v_mfma_f32_16x16x32_bf16 v[60:63], v[156:159], v[136:139], v[60:63]
    s_waitcnt lgkmcnt(7)
    v_mfma_f32_16x16x32_bf16 v[64:67], v[160:163], v[132:135], v[64:67]
    v_mfma_f32_16x16x32_bf16 v[72:75], v[160:163], v[136:139], v[72:75]
    s_waitcnt lgkmcnt(5)
    v_mfma_f32_16x16x32_bf16 v[68:71], v[164:167], v[132:135], v[68:71]
    v_mfma_f32_16x16x32_bf16 v[76:79], v[164:167], v[136:139], v[76:79]
    s_waitcnt lgkmcnt(2)
    v_mfma_f32_16x16x32_bf16 v[80:83], v[168:171], v[140:143], v[80:83]
    s_waitcnt lgkmcnt(0)
    v_mfma_f32_16x16x32_bf16 v[84:87], v[172:175], v[140:143], v[84:87]
    s_add_u32 s68, s65, 0
    s_add_u32 m0, s62, 105984
    s_nop 0
    buffer_load_dwordx4 v252, s[12:15], s68 offen lds
    s_add_u32 s68, s65, 28672
    s_add_u32 m0, s62, 110080
    s_nop 0
    buffer_load_dwordx4 v252, s[12:15], s68 offen lds
    s_mov_b32 exec_lo, 0x00010001
    s_mov_b32 exec_hi, 0x00010001
    ds_write_b128 v24, v[80:83]
    ds_write_b128 v25, v[84:87]
    s_mov_b64 exec, -1
    v_mul_f32 v166, v176, v177
    v_mul_f32 v167, v180, v181
    v_mul_f32 v168, v184, v185
    v_pk_mul_f32 v[56:57], v[56:57], v[180:181] op_sel:[0,1] op_sel_hi:[1,1]
    v_pk_mul_f32 v[58:59], v[58:59], v[180:181] op_sel:[0,1] op_sel_hi:[1,1]
    s_add_u32 s68, s65, 57344
    s_add_u32 m0, s62, 114176
    s_nop 0
    buffer_load_dwordx4 v252, s[12:15], s68 offen lds
    v_pk_mul_f32 v[60:61], v[60:61], v[180:181] op_sel:[0,1] op_sel_hi:[1,1]
    v_pk_mul_f32 v[62:63], v[62:63], v[180:181] op_sel:[0,1] op_sel_hi:[1,1]
    v_pk_mul_f32 v[48:49], v[48:49], v[176:177] op_sel:[0,1] op_sel_hi:[1,1]
    v_pk_mul_f32 v[50:51], v[50:51], v[176:177] op_sel:[0,1] op_sel_hi:[1,1]
    v_pk_mul_f32 v[52:53], v[52:53], v[176:177] op_sel:[0,1] op_sel_hi:[1,1]
    v_pk_mul_f32 v[54:55], v[54:55], v[176:177] op_sel:[0,1] op_sel_hi:[1,1]
    v_pk_mul_f32 v[64:65], v[64:65], v[176:177] op_sel:[0,1] op_sel_hi:[1,1]
    v_pk_mul_f32 v[66:67], v[66:67], v[176:177] op_sel:[0,1] op_sel_hi:[1,1]
    v_pk_mul_f32 v[68:69], v[68:69], v[176:177] op_sel:[0,1] op_sel_hi:[1,1]
    v_pk_mul_f32 v[70:71], v[70:71], v[176:177] op_sel:[0,1] op_sel_hi:[1,1]
    s_add_u32 s68, s65, 86016
    s_add_u32 m0, s62, 118272
    s_nop 0
    buffer_load_dwordx4 v252, s[12:15], s68 offen lds
    v_pk_mul_f32 v[72:73], v[72:73], v[180:181] op_sel:[0,1] op_sel_hi:[1,1]
    v_pk_mul_f32 v[74:75], v[74:75], v[180:181] op_sel:[0,1] op_sel_hi:[1,1]
    v_pk_mul_f32 v[76:77], v[76:77], v[180:181] op_sel:[0,1] op_sel_hi:[1,1]
    v_pk_mul_f32 v[78:79], v[78:79], v[180:181] op_sel:[0,1] op_sel_hi:[1,1]
    v_pk_mul_f32 v[80:81], v[80:81], v[184:185] op_sel:[0,1] op_sel_hi:[1,1]
    v_pk_mul_f32 v[82:83], v[82:83], v[184:185] op_sel:[0,1] op_sel_hi:[1,1]
    s_waitcnt lgkmcnt(0)
    s_barrier
    ds_read_b128 v[96:99], v26 offset:128
    ds_read_b128 v[100:103], v26 offset:192
    ds_read_b128 v[112:115], v24
    ds_read_b128 v[104:107], v26 offset:256
    ds_read_b128 v[108:111], v26 offset:320
    ds_read_b128 v[88:91], v26 offset:0
    ds_read_b128 v[92:95], v26 offset:64
    v_mul_f32 v164, 0x3e8b97f6, v177
    s_add_u32 s68, s65, 114688
    s_add_u32 m0, s62, 122368
    s_nop 0
    buffer_load_dwordx4 v252, s[12:15], s68 offen lds
    v_mul_f32 v165, 0x3e8b97f6, v181
    s_waitcnt lgkmcnt(6)
    v_pk_fma_f32 v[116:117], v[96:97], v[166:167], v[56:57] op_sel:[0,1,0] op_sel_hi:[1,1,1]
    v_pk_fma_f32 v[118:119], v[98:99], v[166:167], v[58:59] op_sel:[0,1,0] op_sel_hi:[1,1,1]
    v_cvt_pk_bf16_f32 v128, v116, v117
    v_cvt_pk_bf16_f32 v129, v118, v119
    s_waitcnt lgkmcnt(5)
    v_pk_fma_f32 v[120:121], v[100:101], v[166:167], v[60:61] op_sel:[0,1,0] op_sel_hi:[1,1,1]
    v_pk_fma_f32 v[122:123], v[102:103], v[166:167], v[62:63] op_sel:[0,1,0] op_sel_hi:[1,1,1]
    v_cvt_pk_bf16_f32 v130, v120, v121
    v_cvt_pk_bf16_f32 v131, v122, v123
    ds_write_b128 v30, v[128:131] offset:1024
    v_pk_fma_f32 v[116:117], v[96:97], v[166:167], v[48:49] op_sel:[0,0,0] op_sel_hi:[1,0,1]
    s_add_u32 s68, s65, 143360
    s_add_u32 m0, s62, 126464
    s_nop 0
    buffer_load_dwordx4 v252, s[12:15], s68 offen lds
    v_pk_fma_f32 v[118:119], v[98:99], v[166:167], v[50:51] op_sel:[0,0,0] op_sel_hi:[1,0,1]
    v_cvt_pk_bf16_f32 v124, v116, v117
    v_cvt_pk_bf16_f32 v125, v118, v119
    v_pk_fma_f32 v[120:121], v[100:101], v[166:167], v[52:53] op_sel:[0,0,0] op_sel_hi:[1,0,1]
    v_pk_fma_f32 v[122:123], v[102:103], v[166:167], v[54:55] op_sel:[0,0,0] op_sel_hi:[1,0,1]
    v_cvt_pk_bf16_f32 v126, v120, v121
    v_cvt_pk_bf16_f32 v127, v122, v123
    s_waitcnt lgkmcnt(5)
    v_pk_fma_f32 v[116:117], v[112:113], v[168:169], v[80:81] op_sel:[0,0,0] op_sel_hi:[1,0,1]
    v_pk_fma_f32 v[118:119], v[114:115], v[168:169], v[82:83] op_sel:[0,0,0] op_sel_hi:[1,0,1]
    v_cvt_pk_bf16_f32 v156, v116, v117
    s_add_u32 s68, s65, 172032
    s_add_u32 m0, s62, 130560
    s_nop 0
    buffer_load_dwordx4 v252, s[12:15], s68 offen lds
    v_cvt_pk_bf16_f32 v157, v118, v119
    ds_write_b64 v27, v[156:157]
    s_waitcnt lgkmcnt(5)
    v_pk_fma_f32 v[116:117], v[104:105], v[166:167], v[64:65] op_sel:[0,0,0] op_sel_hi:[1,0,1]
    v_pk_fma_f32 v[118:119], v[106:107], v[166:167], v[66:67] op_sel:[0,0,0] op_sel_hi:[1,0,1]
    v_cvt_pk_bf16_f32 v158, v116, v117
    v_cvt_pk_bf16_f32 v159, v118, v119
    ds_write_b64 v28, v[158:159] offset:0
    s_waitcnt lgkmcnt(5)
    v_pk_fma_f32 v[120:121], v[108:109], v[166:167], v[68:69] op_sel:[0,0,0] op_sel_hi:[1,0,1]
    v_pk_fma_f32 v[122:123], v[110:111], v[166:167], v[70:71] op_sel:[0,0,0] op_sel_hi:[1,0,1]
    v_cvt_pk_bf16_f32 v160, v120, v121
    s_add_u32 s68, s65, 200704
    s_add_u32 m0, s62, 134656
    s_nop 0
    buffer_load_dwordx4 v252, s[12:15], s68 offen lds
    v_cvt_pk_bf16_f32 v161, v122, v123
    ds_write_b64 v29, v[160:161] offset:0
    v_pk_fma_f32 v[116:117], v[104:105], v[166:167], v[72:73] op_sel:[0,1,0] op_sel_hi:[1,1,1]
    v_pk_fma_f32 v[118:119], v[106:107], v[166:167], v[74:75] op_sel:[0,1,0] op_sel_hi:[1,1,1]
    v_cvt_pk_bf16_f32 v162, v116, v117
    v_cvt_pk_bf16_f32 v163, v118, v119
    ds_write_b64 v28, v[162:163] offset:1024
    v_pk_fma_f32 v[120:121], v[108:109], v[166:167], v[76:77] op_sel:[0,1,0] op_sel_hi:[1,1,1]
    v_pk_fma_f32 v[122:123], v[110:111], v[166:167], v[78:79] op_sel:[0,1,0] op_sel_hi:[1,1,1]
    v_cvt_pk_bf16_f32 v158, v120, v121
    s_add_u32 s68, s65, 229376
    s_add_u32 m0, s62, 138752
    s_nop 0
    buffer_load_dwordx4 v252, s[12:15], s68 offen lds
    v_cvt_pk_bf16_f32 v159, v122, v123
    ds_write_b64 v29, v[158:159] offset:1024
    s_waitcnt lgkmcnt(7)
    v_pk_fma_f32 v[116:117], v[88:89], v[176:177], v[32:33] op_sel:[0,0,0] op_sel_hi:[1,0,1]
    v_pk_fma_f32 v[118:119], v[90:91], v[176:177], v[34:35] op_sel:[0,0,0] op_sel_hi:[1,0,1]
    v_cvt_pk_bf16_f32 v132, v116, v117
    v_cvt_pk_bf16_f32 v133, v118, v119
    s_waitcnt lgkmcnt(6)
    v_pk_fma_f32 v[120:121], v[92:93], v[176:177], v[36:37] op_sel:[0,0,0] op_sel_hi:[1,0,1]
    v_pk_fma_f32 v[122:123], v[94:95], v[176:177], v[38:39] op_sel:[0,0,0] op_sel_hi:[1,0,1]
    v_cvt_pk_bf16_f32 v134, v120, v121
    v_cvt_pk_bf16_f32 v135, v122, v123
    s_add_u32 s68, s65, 258048
    s_add_u32 m0, s62, 142848
    s_nop 0
    buffer_load_dwordx4 v252, s[12:15], s68 offen lds
    v_cndmask_b32 v134, v134, 0, s[98:99]
    v_cndmask_b32 v135, v135, 0, s[98:99]
    v_pk_fma_f32 v[116:117], v[88:89], v[180:181], v[40:41] op_sel:[0,0,0] op_sel_hi:[1,0,1]
    v_pk_fma_f32 v[118:119], v[90:91], v[180:181], v[42:43] op_sel:[0,0,0] op_sel_hi:[1,0,1]
    v_cvt_pk_bf16_f32 v136, v116, v117
    v_cvt_pk_bf16_f32 v137, v118, v119
    v_pk_fma_f32 v[120:121], v[92:93], v[180:181], v[44:45] op_sel:[0,0,0] op_sel_hi:[1,0,1]
    v_pk_fma_f32 v[122:123], v[94:95], v[180:181], v[46:47] op_sel:[0,0,0] op_sel_hi:[1,0,1]
    v_cvt_pk_bf16_f32 v138, v120, v121
    v_cvt_pk_bf16_f32 v139, v122, v123
    s_add_u32 s68, s65, 286720
    s_add_u32 m0, s62, 146944
    s_nop 0
    buffer_load_dwordx4 v252, s[12:15], s68 offen lds
    v_cndmask_b32 v138, v138, 0, s[98:99]
    v_cndmask_b32 v139, v139, 0, s[98:99]
    s_waitcnt lgkmcnt(0)
    s_barrier
    ds_read_b128 v[140:143], v30
    ds_read_b64_tr_b16 v[144:145], v210 offset:0
    ds_read_b64_tr_b16 v[146:147], v210 offset:1024
    ds_read_b64_tr_b16 v[148:149], v210 offset:2048
    ds_read_b64_tr_b16 v[150:151], v211 offset:0
    ds_read_b64_tr_b16 v[152:153], v211 offset:1024
    ds_read_b64_tr_b16 v[154:155], v211 offset:2048
    v_mfma_f32_16x16x32_bf16 v[44:47], v[128:131], v[136:139], 0
    s_add_u32 s68, s65, 315392
    s_add_u32 m0, s62, 151040
    s_nop 0
    buffer_load_dwordx4 v252, s[12:15], s68 offen lds
    v_mfma_f32_16x16x32_bf16 v[36:39], v[124:127], v[132:135], 0
    v_mfma_f32_16x16x32_bf16 v[40:43], v[124:127], v[136:139], 0
    s_waitcnt lgkmcnt(6)
    v_mfma_f32_16x16x32_bf16 v[32:35], v[140:143], v[132:135], 0
    s_nop 0
    v_pk_fma_f32 v[44:45], v[44:45], v[164:165], v[196:197] op_sel:[0,1,0] op_sel_hi:[1,1,1]
    v_pk_fma_f32 v[46:47], v[46:47], v[164:165], v[198:199] op_sel:[0,1,0] op_sel_hi:[1,1,1]
    s_nop 3
    v_pk_fma_f32 v[40:41], v[40:41], v[164:165], v[192:193] op_sel:[0,1,0] op_sel_hi:[1,1,1]
    s_nop 2
    v_pk_fma_f32 v[42:43], v[42:43], v[164:165], v[194:195] op_sel:[0,1,0] op_sel_hi:[1,1,1]
    s_nop 0
    v_pk_fma_f32 v[36:37], v[36:37], v[164:165], v[196:197] op_sel:[0,0,0] op_sel_hi:[1,0,1]
    v_pk_fma_f32 v[38:39], v[38:39], v[164:165], v[198:199] op_sel:[0,0,0] op_sel_hi:[1,0,1]
    s_nop 1
    v_pk_fma_f32 v[32:33], v[32:33], v[164:165], v[200:201] op_sel:[0,0,0] op_sel_hi:[1,0,1]
    s_add_u32 s68, s65, 344064
    s_add_u32 m0, s62, 155136
    s_nop 0
    buffer_load_dwordx4 v252, s[12:15], s68 offen lds
    v_pk_fma_f32 v[34:35], v[34:35], v[164:165], v[202:203] op_sel:[0,0,0] op_sel_hi:[1,0,1]
    v_max3_f32 v50, v40, v41, v42
    v_max3_f32 v51, v43, v44, v45
    v_max3_f32 v50, v50, v46, v47
    v_max_f32 v50, v50, v51
    v_max3_f32 v48, v32, v33, v34
    v_max3_f32 v49, v35, v36, v37
    v_max3_f32 v48, v48, v38, v39
    v_max_f32 v48, v48, v49
    v_mov_b32 v51, v50
    s_add_u32 s68, s65, 372736
    s_add_u32 m0, s62, 159232
    s_nop 0
    buffer_load_dwordx4 v252, s[12:15], s68 offen lds
    v_mov_b32 v49, v48
    v_permlane32_swap_b32 v50, v51
    s_nop 0
    v_permlane32_swap_b32 v48, v49
    v_max_f32 v50, v50, v51
    v_max_f32 v48, v48, v49
    v_mov_b32 v51, v50
    v_mov_b32 v49, v48
    s_nop 0
    v_permlane16_swap_b32 v50, v51
    s_nop 0
    v_permlane16_swap_b32 v48, v49
    v_max_f32 v50, v50, v51
    s_mov_b32 s68, 0
    s_add_u32 m0, s64, 0
    s_nop 0
    buffer_load_dwordx4 v253, s[16:19], s68 offen lds
    v_max_f32 v48, v48, v49
    v_pk_add_f32 v[40:41], v[40:41], v[50:51] op_sel:[0,0] op_sel_hi:[1,0] neg_lo:[0,1] neg_hi:[0,1]
    v_pk_add_f32 v[42:43], v[42:43], v[50:51] op_sel:[0,0] op_sel_hi:[1,0] neg_lo:[0,1] neg_hi:[0,1]
    v_pk_add_f32 v[44:45], v[44:45], v[50:51] op_sel:[0,0] op_sel_hi:[1,0] neg_lo:[0,1] neg_hi:[0,1]
    v_pk_add_f32 v[46:47], v[46:47], v[50:51] op_sel:[0,0] op_sel_hi:[1,0] neg_lo:[0,1] neg_hi:[0,1]
    v_pk_add_f32 v[32:33], v[32:33], v[48:49] op_sel:[0,0] op_sel_hi:[1,0] neg_lo:[0,1] neg_hi:[0,1]
    v_pk_add_f32 v[34:35], v[34:35], v[48:49] op_sel:[0,0] op_sel_hi:[1,0] neg_lo:[0,1] neg_hi:[0,1]
    v_pk_add_f32 v[36:37], v[36:37], v[48:49] op_sel:[0,0] op_sel_hi:[1,0] neg_lo:[0,1] neg_hi:[0,1]
    v_pk_add_f32 v[38:39], v[38:39], v[48:49] op_sel:[0,0] op_sel_hi:[1,0] neg_lo:[0,1] neg_hi:[0,1]
    v_exp_f32 v40, v40
    s_add_u32 m0, s64, 1024
    s_mov_b64 exec, s[66:67]
    buffer_load_dwordx4 v254, s[16:19], s68 offen lds
    s_mov_b64 exec, -1
    v_exp_f32 v41, v41
    v_exp_f32 v42, v42
    v_exp_f32 v43, v43
    v_exp_f32 v44, v44
    v_exp_f32 v45, v45
    v_exp_f32 v46, v46
    v_exp_f32 v47, v47
    v_cvt_pk_bf16_f32 v60, v40, v41
    v_cvt_pk_bf16_f32 v61, v42, v43
    v_cvt_pk_bf16_f32 v62, v44, v45
    s_mov_b32 s68, 114688
    s_add_u32 m0, s64, 7168
    s_nop 0
    buffer_load_dwordx4 v253, s[16:19], s68 offen lds
    v_cvt_pk_bf16_f32 v63, v46, v47
    s_waitcnt lgkmcnt(3)
    s_nop 0
    v_mfma_f32_16x16x32_bf16 v[72:75], v[146:149], v[60:63], 0
    s_waitcnt lgkmcnt(0)
    v_mfma_f32_16x16x32_bf16 v[76:79], v[152:155], v[60:63], 0
    v_exp_f32 v32, v32
    v_exp_f32 v33, v33
    v_exp_f32 v34, v34
    v_exp_f32 v35, v35
    v_exp_f32 v36, v36
    v_exp_f32 v37, v37
    v_exp_f32 v38, v38
    s_add_u32 m0, s64, 8192
    s_mov_b64 exec, s[66:67]
    buffer_load_dwordx4 v254, s[16:19], s68 offen lds
    s_mov_b64 exec, -1
    v_exp_f32 v39, v39
    v_cvt_pk_bf16_f32 v56, v32, v33
    v_cvt_pk_bf16_f32 v57, v34, v35
    v_cvt_pk_bf16_f32 v58, v36, v37
    v_cvt_pk_bf16_f32 v59, v38, v39
    s_nop 1
    v_mfma_f32_16x16x32_bf16 v[64:67], v[144:147], v[56:59], 0
    s_nop 0
    v_mfma_f32_16x16x32_bf16 v[68:71], v[150:153], v[56:59], 0
    v_pk_add_f32 v[40:41], v[40:41], v[42:43]
    v_pk_add_f32 v[44:45], v[44:45], v[46:47]
    v_pk_add_f32 v[40:41], v[40:41], v[44:45]
    v_add_f32 v54, v40, v41
    v_pk_add_f32 v[32:33], v[32:33], v[34:35]
    v_pk_add_f32 v[36:37], v[36:37], v[38:39]
    v_pk_add_f32 v[32:33], v[32:33], v[36:37]
    v_add_f32 v52, v32, v33
    v_mov_b32 v55, v54
    v_mov_b32 v53, v52
    s_nop 0
    v_permlane32_swap_b32 v54, v55
    s_nop 0
    v_permlane32_swap_b32 v52, v53
    v_add_f32 v54, v54, v55
    v_add_f32 v52, v52, v53
    v_mov_b32 v55, v54
    v_mov_b32 v53, v52
    s_nop 0
    v_permlane16_swap_b32 v54, v55
    s_nop 0
    v_permlane16_swap_b32 v52, v53
    v_add_f32 v54, v54, v55
    v_add_f32 v52, v52, v53
    v_rcp_f32 v54, v54
    v_rcp_f32 v52, v52
    v_pk_mul_f32 v[72:73], v[72:73], v[54:55] op_sel:[0,0] op_sel_hi:[1,0]
    v_pk_mul_f32 v[74:75], v[74:75], v[54:55] op_sel:[0,0] op_sel_hi:[1,0]
    v_pk_mul_f32 v[76:77], v[76:77], v[54:55] op_sel:[0,0] op_sel_hi:[1,0]
    v_pk_mul_f32 v[78:79], v[78:79], v[54:55] op_sel:[0,0] op_sel_hi:[1,0]
    v_cvt_pk_bf16_f32 v84, v72, v73
    v_cvt_pk_bf16_f32 v85, v74, v75
    v_cvt_pk_bf16_f32 v86, v76, v77
    v_cvt_pk_bf16_f32 v87, v78, v79
    v_cndmask_b32 v86, v86, 0, s[98:99]
    v_cndmask_b32 v87, v87, 0, s[98:99]
    v_pk_mul_f32 v[64:65], v[64:65], v[52:53] op_sel:[0,0] op_sel_hi:[1,0]
    v_pk_mul_f32 v[66:67], v[66:67], v[52:53] op_sel:[0,0] op_sel_hi:[1,0]
    v_pk_mul_f32 v[68:69], v[68:69], v[52:53] op_sel:[0,0] op_sel_hi:[1,0]
    v_pk_mul_f32 v[70:71], v[70:71], v[52:53] op_sel:[0,0] op_sel_hi:[1,0]
    v_cvt_pk_bf16_f32 v80, v64, v65
    v_cvt_pk_bf16_f32 v81, v66, v67
    v_cvt_pk_bf16_f32 v82, v68, v69
    v_cvt_pk_bf16_f32 v83, v70, v71
    v_cndmask_b32 v82, v82, 0, s[98:99]
    v_cndmask_b32 v83, v83, 0, s[98:99]
    s_mov_b32 s56, 16384
    buffer_store_dwordx4 v[84:87], v31, s[28:31], s56 offen sc1
    s_mov_b32 s56, 0
    buffer_store_dwordx4 v[80:83], v31, s[28:31], s56 offen sc1
    s_mov_b32 s68, 229376
    s_add_u32 m0, s64, 14336
    s_nop 0
    buffer_load_dwordx4 v253, s[16:19], s68 offen lds
    s_add_u32 m0, s64, 15360
    s_mov_b64 exec, s[66:67]
    buffer_load_dwordx4 v254, s[16:19], s68 offen lds
    s_mov_b64 exec, -1
    s_mov_b32 s68, 344064
    s_add_u32 m0, s64, 21504
    s_nop 0
    buffer_load_dwordx4 v253, s[16:19], s68 offen lds
    s_add_u32 m0, s64, 22528
    s_mov_b64 exec, s[66:67]
    buffer_load_dwordx4 v254, s[16:19], s68 offen lds
    s_mov_b64 exec, -1
    s_mov_b32 s68, 458752
    s_add_u32 m0, s64, 28672
    s_nop 0
    buffer_load_dwordx4 v253, s[16:19], s68 offen lds
    s_add_u32 m0, s64, 29696
    s_mov_b64 exec, s[66:67]
    buffer_load_dwordx4 v254, s[16:19], s68 offen lds
    s_mov_b64 exec, -1
    s_mov_b32 s68, 573440
    s_add_u32 m0, s64, 35840
    s_nop 0
    buffer_load_dwordx4 v253, s[16:19], s68 offen lds
    s_add_u32 m0, s64, 36864
    s_mov_b64 exec, s[66:67]
    buffer_load_dwordx4 v254, s[16:19], s68 offen lds
    s_mov_b64 exec, -1
    s_waitcnt vmcnt(8)
    s_cmp_eq_u32 s37, 1
    s_cbranch_scc0 L_slow_o
    s_lshl_b32 s40, s32, 12
    s_lshl_b32 s41, s33, 4
    s_add_u32 s40, s40, s41
    s_lshl_b32 s41, s34, 2
    s_add_u32 s40, s40, s41
    s_add_u32 s40, s40, 1024
    v_mov_b32 v20, s35
    s_mov_b64 exec, 1
    buffer_store_dword v20, off, s[28:31], s40
    s_mov_b64 exec, -1
    s_branch L_join_o
L_slow_o:
    s_lshl_b32 s40, s32, 12
    s_lshl_b32 s41, s33, 4
    s_add_u32 s40, s40, s41
    s_lshl_b32 s41, s34, 2
    s_add_u32 s40, s40, s41
    s_add_u32 s40, s40, 1024
    v_mov_b32 v20, s35
    s_mov_b64 exec, 1
    buffer_store_dword v20, off, s[28:31], s40 sc1
    s_mov_b64 exec, -1
L_join_o:
    s_lshl_b32 s68, s32, 12
    s_add_u32 s68, s68, 1024
    v_lshl_add_u32 v9, v0, 2, s68
    buffer_load_dword v10, v9, s[28:31], 0 offen sc1
    v_bfe_u32 v19, v0, 2, 2
    v_lshrrev_b32 v20, 5, v0
    v_lshl_add_u32 v20, v20, 3, v19
    v_lshlrev_b32 v20, 7, v20
    v_lshrrev_b32 v19, 1, v19
    v_xor_b32 v19, s59, v19
    v_lshl_add_u32 v20, v19, 6, v20
    v_bfe_u32 v19, v0, 4, 1
    v_lshl_add_u32 v20, v19, 5, v20
    v_and_b32 v19, 3, v0
    v_lshl_add_u32 v20, v19, 3, v20
    s_mul_i32 s42, s59, 28672
    s_add_u32 s42, s42, 102400
    v_add_u32 v250, s42, v20
    v_lshrrev_b32 v19, 3, v0
    v_mul_u32_u24 v19, 896, v19
    v_bfe_u32 v20, v0, 4, 1
    v_lshlrev_b32 v20, 2, v20
    v_and_b32 v21, 7, v0
    v_xor_b32 v20, v20, v21
    v_lshl_add_u32 v19, v20, 4, v19
    s_lshl_b32 s69, s58, 7
    v_add_u32 v255, s69, v19
    v_lshlrev_b32 v22, 4, v0
    s_mul_i32 s40, s32, 0x70000
    s_mul_i32 s41, s34, 114688
    s_add_u32 s40, s40, s41
    s_mul_i32 s41, s33, 7168
    s_add_u32 s40, s40, s41
    s_add_u32 s40, s40, 5242880
    v_add_u32 v248, s40, v22
    s_mul_i32 s40, s32, 0x1C000
    s_add_u32 s40, s40, 3145728
    s_mul_i32 s41, s34, 28672
    s_add_u32 s40, s40, s41
    v_add_u32 v241, s40, v22
    s_lshl_b32 s40, s32, 13
    s_add_u32 s40, s40, 131072
    s_lshl_b32 s42, s34, 8
    s_add_u32 s42, s42, s40
    v_lshlrev_b32 v19, 3, v17
    v_lshl_add_u32 v20, v18, 10, v19
    v_add_u32 v242, s42, v20
    v_lshrrev_b32 v19, 2, v0
    v_mul_u32_u24 v19, 224, v19
    v_and_b32 v20, 3, v0
    v_lshl_add_u32 v239, v20, 3, v19
    v_add_u32 v240, 50176, v239
    s_lshl_b32 s40, s34, 6
    v_add_u32 v243, s40, v239
    s_add_u32 s41, s40, 32
    s_min_u32 s41, s41, 192
    v_add_u32 v244, s41, v239
    v_lshlrev_b32 v19, 4, v18
    v_add_u32 v247, 100352, v19
    s_lshl_b32 s40, s40, 1
    v_add_u32 v245, s40, v247
    s_lshl_b32 s41, s41, 1
    v_add_u32 v246, s41, v247
    buffer_load_dword v11, v9, s[28:31], 0 offen sc1
    s_cmp_ge_u32 s33, 14
    s_cbranch_scc1 L_skipB
    v_lshrrev_b32 v19, 2, v0
    v_lshlrev_b32 v19, 7, v19
    v_and_b32 v20, 3, v0
    v_lshl_add_u32 v19, v20, 3, v19
    v_bfe_u32 v20, v0, 3, 2
    s_mul_i32 s40, s59, 28672
    s_add_u32 s40, s40, 105984
    v_xor_b32 v21, 0, v20
    v_lshl_add_u32 v21, v21, 5, v19
    v_add_u32 v213, s40, v21
    v_xor_b32 v21, 1, v20
    v_lshl_add_u32 v21, v21, 5, v19
    v_add_u32 v214, s40, v21
    v_xor_b32 v21, 2, v20
    v_lshl_add_u32 v21, v21, 5, v19
    v_add_u32 v215, s40, v21
    v_xor_b32 v21, 3, v20
    v_lshl_add_u32 v21, v21, 5, v19
    v_add_u32 v216, s40, v21
    s_lshl_b32 s40, s61, 4
    s_add_u32 s40, s40, s38
    v_add_u32 v19, s40, v17
    v_mul_u32_u24 v19, 896, v19
    s_lshl_b32 s40, s58, 7
    v_add_u32 v19, s40, v19
    v_lshl_add_u32 v222, v18, 3, v19
    v_lshlrev_b32 v22, 4, v0
    s_mul_i32 s40, s32, 0x1C000
    s_add_u32 s40, s40, 3145728
    s_mul_i32 s41, s61, 14336
    s_add_u32 s41, s40, s41
    s_lshl_b32 s42, s58, 11
    s_add_u32 s41, s41, s42
    v_add_u32 v223, s41, v22
    s_lshl_b32 s40, s32, 17
    s_lshl_b32 s41, s59, 13
    s_add_u32 s40, s40, s41
    s_add_u32 s40, s40, 1048576
    s_lshl_b32 s41, s61, 14
    s_add_u32 s41, s41, s40
    v_add_u32 v217, s41, v22
    s_xor_b32 s42, s61, 1
    s_lshl_b32 s41, s42, 14
    s_add_u32 s41, s41, s40
    v_add_u32 v218, s41, v22
    s_lshl_b32 s40, s62, 2
    s_add_u32 s40, s40, 105984
    v_add_u32 v220, s40, v22
    s_xor_b32 s40, s34, 2
    s_lshl_b32 s40, s40, 12
    s_add_u32 s40, s40, 105984
    v_add_u32 v221, s40, v22
    s_lshl_b32 s40, s32, 13
    s_add_u32 s40, s40, 131072
    s_lshl_b32 s41, s61, 7
    s_add_u32 s41, s41, s40
    s_lshl_b32 s42, s58, 10
    s_add_u32 s41, s41, s42
    v_lshlrev_b32 v19, 3, v17
    v_add_u32 v19, s41, v19
    v_mov_b32 v20, 0x80000000
    v_cmp_gt_u32 s[42:43], 16, v0
    s_nop 1
    v_cndmask_b32 v219, v20, v19, s[42:43]
    buffer_load_dwordx2 v[160:161], v222, s[4:7], 0 offen offset:0
    buffer_load_dwordx2 v[162:163], v222, s[4:7], 0 offen offset:32
    buffer_load_dwordx2 v[164:165], v222, s[4:7], 0 offen offset:64
    buffer_load_dwordx2 v[166:167], v222, s[4:7], 0 offen offset:96
    s_mov_b32 s44, 0xffffffff
    s_mov_b32 s45, 0xffffffff
    s_waitcnt vmcnt(5)
    v_cmp_eq_u32 vcc, s35, v10
    s_nop 0
    s_and_b64 vcc, vcc, s[44:45]
    s_cmp_eq_u64 vcc, s[44:45]
    s_cbranch_scc1 L_pollok_f1
    s_waitcnt vmcnt(4)
    v_cmp_eq_u32 vcc, s35, v11
    s_nop 0
    s_and_b64 vcc, vcc, s[44:45]
    s_cmp_eq_u64 vcc, s[44:45]
    s_cbranch_scc1 L_pollok_f1
    s_mov_b32 s42, 0
    buffer_load_dword v20, v9, s[28:31], 0 offen sc1
    buffer_load_dword v21, v9, s[28:31], 0 offen sc1
L_poll_f1:
    buffer_load_dword v22, v9, s[28:31], 0 offen sc1
    s_waitcnt vmcnt(2)
    v_cmp_eq_u32 vcc, s35, v20
    s_nop 0
    s_and_b64 vcc, vcc, s[44:45]
    s_cmp_eq_u64 vcc, s[44:45]
    s_cbranch_scc1 L_pollok_f1
    buffer_load_dword v20, v9, s[28:31], 0 offen sc1
    s_waitcnt vmcnt(2)
    v_cmp_eq_u32 vcc, s35, v21
    s_nop 0
    s_and_b64 vcc, vcc, s[44:45]
    s_cmp_eq_u64 vcc, s[44:45]
    s_cbranch_scc1 L_pollok_f1
    buffer_load_dword v21, v9, s[28:31], 0 offen sc1
    s_waitcnt vmcnt(2)
    v_cmp_eq_u32 vcc, s35, v22
    s_nop 0
    s_and_b64 vcc, vcc, s[44:45]
    s_cmp_eq_u64 vcc, s[44:45]
    s_cbranch_scc1 L_pollok_f1
    s_add_u32 s42, s42, 1
    s_cmp_lt_u32 s42, 0x40000
    s_cbranch_scc1 L_poll_f1
L_pollok_f1:
    s_or_b32 s41, s33, s34
    s_cmp_eq_u32 s41, 0
    s_cbranch_scc0 L_noepoch
    s_lshl_b32 s40, s32, 12
    v_mov_b32 v23, s35
    s_mov_b64 exec, 1
    buffer_store_dword v23, off, s[28:31], s40 sc1
    s_mov_b64 exec, -1
L_noepoch:
    s_movk_i32 s69, 4096
    buffer_load_dwordx4 v[96:99], v217, s[28:31], 0 offen offset:0 sc1
    buffer_load_dwordx4 v[100:103], v218, s[28:31], 0 offen offset:0 sc1
    buffer_load_dwordx4 v[104:107], v217, s[28:31], 0 offen offset:1024 sc1
    buffer_load_dwordx4 v[108:111], v218, s[28:31], 0 offen offset:1024 sc1
    buffer_load_dwordx4 v[112:115], v217, s[28:31], 0 offen offset:2048 sc1
    buffer_load_dwordx4 v[116:119], v218, s[28:31], 0 offen offset:2048 sc1
    s_barrier
    ds_read_b64_tr_b16 v[64:65], v213 offset:0
    ds_read_b64_tr_b16 v[66:67], v213 offset:2048
    ds_read_b64_tr_b16 v[68:69], v214 offset:0
    ds_read_b64_tr_b16 v[70:71], v214 offset:2048
    ds_read_b64_tr_b16 v[72:73], v215 offset:0
    ds_read_b64_tr_b16 v[74:75], v215 offset:2048
    ds_read_b64_tr_b16 v[76:77], v216 offset:0
    ds_read_b64_tr_b16 v[78:79], v216 offset:2048
    s_waitcnt vmcnt(5) lgkmcnt(6)
    v_mfma_f32_16x16x32_bf16 v[32:35], v[64:67], v[96:99], 0
    ds_read_b64_tr_b16 v[80:81], v215 offset:3584
    s_waitcnt vmcnt(4)
    v_mfma_f32_16x16x32_bf16 v[48:51], v[64:67], v[100:103], 0
    ds_read_b64_tr_b16 v[82:83], v215 offset:5632
    s_waitcnt lgkmcnt(6)
    v_mfma_f32_16x16x32_bf16 v[36:39], v[68:71], v[96:99], 0
    ds_read_b64_tr_b16 v[84:85], v216 offset:3584
    v_mfma_f32_16x16x32_bf16 v[52:55], v[68:71], v[100:103], 0
    ds_read_b64_tr_b16 v[86:87], v216 offset:5632
    buffer_load_dwordx4 v[120:123], v217, s[28:31], 0 offen offset:3072 sc1
    s_waitcnt lgkmcnt(6)
    v_mfma_f32_16x16x32_bf16 v[40:43], v[72:75], v[96:99], 0
    ds_read_b64_tr_b16 v[88:89], v213 offset:3584
    v_mfma_f32_16x16x32_bf16 v[56:59], v[72:75], v[100:103], 0
    ds_read_b64_tr_b16 v[90:91], v213 offset:5632
    s_waitcnt lgkmcnt(6)
    v_mfma_f32_16x16x32_bf16 v[44:47], v[76:79], v[96:99], 0
    ds_read_b64_tr_b16 v[92:93], v214 offset:3584
    v_mfma_f32_16x16x32_bf16 v[60:63], v[76:79], v[100:103], 0
    ds_read_b64_tr_b16 v[94:95], v214 offset:5632
    buffer_load_dwordx4 v[124:127], v218, s[28:31], 0 offen offset:3072 sc1
    s_waitcnt vmcnt(5) lgkmcnt(6)
    v_mfma_f32_16x16x32_bf16 v[32:35], v[80:83], v[104:107], v[32:35]
    ds_read_b64_tr_b16 v[64:65], v213 offset:7168
    s_waitcnt vmcnt(4)
    v_mfma_f32_16x16x32_bf16 v[48:51], v[80:83], v[108:111], v[48:51]
    ds_read_b64_tr_b16 v[66:67], v213 offset:9216
    buffer_load_dwordx4 v[128:131], v217, s[28:31], s69 offen offset:0 sc1
    s_waitcnt lgkmcnt(6)
    v_mfma_f32_16x16x32_bf16 v[36:39], v[84:87], v[104:107], v[36:39]
    ds_read_b64_tr_b16 v[68:69], v214 offset:7168
    buffer_load_dwordx4 v[132:135], v218, s[28:31], s69 offen offset:0 sc1
    v_mfma_f32_16x16x32_bf16 v[52:55], v[84:87], v[108:111], v[52:55]
    ds_read_b64_tr_b16 v[70:71], v214 offset:9216
    v_lshlrev_b32 v192, 16, v160
    s_waitcnt lgkmcnt(6)
    v_mfma_f32_16x16x32_bf16 v[40:43], v[88:91], v[104:107], v[40:43]
    ds_read_b64_tr_b16 v[72:73], v215 offset:7168
    v_mfma_f32_16x16x32_bf16 v[56:59], v[88:91], v[108:111], v[56:59]
    ds_read_b64_tr_b16 v[74:75], v215 offset:9216
    v_and_b32 v193, 0xffff0000, v160
    s_waitcnt lgkmcnt(6)
    v_mfma_f32_16x16x32_bf16 v[44:47], v[92:95], v[104:107], v[44:47]
    ds_read_b64_tr_b16 v[76:77], v216 offset:7168
    v_lshlrev_b32 v194, 16, v161
    v_mfma_f32_16x16x32_bf16 v[60:63], v[92:95], v[108:111], v[60:63]
    ds_read_b64_tr_b16 v[78:79], v216 offset:9216
    v_and_b32 v195, 0xffff0000, v161
    s_waitcnt vmcnt(5) lgkmcnt(6)
    v_mfma_f32_16x16x32_bf16 v[32:35], v[64:67], v[112:115], v[32:35]
    ds_read_b64_tr_b16 v[80:81], v215 offset:10752
    s_waitcnt vmcnt(4)
    v_mfma_f32_16x16x32_bf16 v[48:51], v[64:67], v[116:119], v[48:51]
    ds_read_b64_tr_b16 v[82:83], v215 offset:12800
    buffer_load_dwordx4 v[136:139], v217, s[28:31], s69 offen offset:1024 sc1
    s_waitcnt lgkmcnt(6)
    v_mfma_f32_16x16x32_bf16 v[36:39], v[68:71], v[112:115], v[36:39]
    ds_read_b64_tr_b16 v[84:85], v216 offset:10752
    buffer_load_dwordx4 v[140:143], v218, s[28:31], s69 offen offset:1024 sc1
    v_mfma_f32_16x16x32_bf16 v[52:55], v[68:71], v[116:119], v[52:55]
    ds_read_b64_tr_b16 v[86:87], v216 offset:12800
    v_lshlrev_b32 v196, 16, v162
    s_waitcnt lgkmcnt(6)
    v_mfma_f32_16x16x32_bf16 v[40:43], v[72:75], v[112:115], v[40:43]
    ds_read_b64_tr_b16 v[88:89], v213 offset:10752
    v_mfma_f32_16x16x32_bf16 v[56:59], v[72:75], v[116:119], v[56:59]
    ds_read_b64_tr_b16 v[90:91], v213 offset:12800
    v_and_b32 v197, 0xffff0000, v162
    s_waitcnt lgkmcnt(6)
    v_mfma_f32_16x16x32_bf16 v[44:47], v[76:79], v[112:115], v[44:47]
    ds_read_b64_tr_b16 v[92:93], v214 offset:10752
    v_lshlrev_b32 v198, 16, v163
    v_mfma_f32_16x16x32_bf16 v[60:63], v[76:79], v[116:119], v[60:63]
    ds_read_b64_tr_b16 v[94:95], v214 offset:12800
    v_and_b32 v199, 0xffff0000, v163
    s_waitcnt vmcnt(5) lgkmcnt(6)
    v_mfma_f32_16x16x32_bf16 v[32:35], v[80:83], v[120:123], v[32:35]
    ds_read_b64_tr_b16 v[64:65], v213 offset:14336
    s_waitcnt vmcnt(4)
    v_mfma_f32_16x16x32_bf16 v[48:51], v[80:83], v[124:127], v[48:51]
    ds_read_b64_tr_b16 v[66:67], v213 offset:16384
    buffer_load_dwordx4 v[144:147], v217, s[28:31], s69 offen offset:2048 sc1
    s_waitcnt lgkmcnt(6)
    v_mfma_f32_16x16x32_bf16 v[36:39], v[84:87], v[120:123], v[36:39]
    ds_read_b64_tr_b16 v[68:69], v214 offset:14336
    buffer_load_dwordx4 v[148:151], v218, s[28:31], s69 offen offset:2048 sc1
    v_mfma_f32_16x16x32_bf16 v[52:55], v[84:87], v[124:127], v[52:55]
    ds_read_b64_tr_b16 v[70:71], v214 offset:16384
    v_lshlrev_b32 v200, 16, v164
    s_waitcnt lgkmcnt(6)
    v_mfma_f32_16x16x32_bf16 v[40:43], v[88:91], v[120:123], v[40:43]
    ds_read_b64_tr_b16 v[72:73], v215 offset:14336
    v_mfma_f32_16x16x32_bf16 v[56:59], v[88:91], v[124:127], v[56:59]
    ds_read_b64_tr_b16 v[74:75], v215 offset:16384
    v_and_b32 v201, 0xffff0000, v164
    s_waitcnt lgkmcnt(6)
    v_mfma_f32_16x16x32_bf16 v[44:47], v[92:95], v[120:123], v[44:47]
    ds_read_b64_tr_b16 v[76:77], v216 offset:14336
    v_lshlrev_b32 v202, 16, v165
    v_mfma_f32_16x16x32_bf16 v[60:63], v[92:95], v[124:127], v[60:63]
    ds_read_b64_tr_b16 v[78:79], v216 offset:16384
    v_and_b32 v203, 0xffff0000, v165
    s_waitcnt vmcnt(5) lgkmcnt(6)
    v_mfma_f32_16x16x32_bf16 v[32:35], v[64:67], v[128:131], v[32:35]
    ds_read_b64_tr_b16 v[80:81], v215 offset:17920
    s_waitcnt vmcnt(4)
    v_mfma_f32_16x16x32_bf16 v[48:51], v[64:67], v[132:135], v[48:51]
    ds_read_b64_tr_b16 v[82:83], v215 offset:19968
    buffer_load_dwordx4 v[152:155], v217, s[28:31], s69 offen offset:3072 sc1
    s_waitcnt lgkmcnt(6)
    v_mfma_f32_16x16x32_bf16 v[36:39], v[68:71], v[128:131], v[36:39]
    ds_read_b64_tr_b16 v[84:85], v216 offset:17920
    buffer_load_dwordx4 v[156:159], v218, s[28:31], s69 offen offset:3072 sc1
    v_mfma_f32_16x16x32_bf16 v[52:55], v[68:71], v[132:135], v[52:55]
    ds_read_b64_tr_b16 v[86:87], v216 offset:19968
    v_lshlrev_b32 v204, 16, v166
    s_waitcnt lgkmcnt(6)
    v_mfma_f32_16x16x32_bf16 v[40:43], v[72:75], v[128:131], v[40:43]
    ds_read_b64_tr_b16 v[88:89], v213 offset:17920
    v_mfma_f32_16x16x32_bf16 v[56:59], v[72:75], v[132:135], v[56:59]
    ds_read_b64_tr_b16 v[90:91], v213 offset:19968
    v_and_b32 v205, 0xffff0000, v166
    s_waitcnt lgkmcnt(6)
    v_mfma_f32_16x16x32_bf16 v[44:47], v[76:79], v[128:131], v[44:47]
    ds_read_b64_tr_b16 v[92:93], v214 offset:17920
    v_lshlrev_b32 v206, 16, v167
    v_mfma_f32_16x16x32_bf16 v[60:63], v[76:79], v[132:135], v[60:63]
    ds_read_b64_tr_b16 v[94:95], v214 offset:19968
    v_and_b32 v207, 0xffff0000, v167
    s_waitcnt vmcnt(5) lgkmcnt(6)
    v_mfma_f32_16x16x32_bf16 v[32:35], v[80:83], v[136:139], v[32:35]
    ds_read_b64_tr_b16 v[64:65], v213 offset:21504
    s_mov_b32 s68, 688128
    s_waitcnt vmcnt(4)
    v_mfma_f32_16x16x32_bf16 v[48:51], v[80:83], v[140:143], v[48:51]
    ds_read_b64_tr_b16 v[66:67], v213 offset:23552
    s_add_u32 m0, s64, 43008
    s_nop 0
    buffer_load_dwordx4 v253, s[16:19], s68 offen lds
    s_waitcnt lgkmcnt(6)
    v_mfma_f32_16x16x32_bf16 v[36:39], v[84:87], v[136:139], v[36:39]
    ds_read_b64_tr_b16 v[68:69], v214 offset:21504
    s_add_u32 m0, s64, 44032
    v_mfma_f32_16x16x32_bf16 v[52:55], v[84:87], v[140:143], v[52:55]
    ds_read_b64_tr_b16 v[70:71], v214 offset:23552
    s_mov_b64 exec, s[66:67]
    buffer_load_dwordx4 v254, s[16:19], s68 offen lds
    s_mov_b64 exec, -1
    s_mov_b32 s68, 802816
    s_waitcnt lgkmcnt(6)
    v_mfma_f32_16x16x32_bf16 v[40:43], v[88:91], v[136:139], v[40:43]
    ds_read_b64_tr_b16 v[72:73], v215 offset:21504
    s_add_u32 m0, s64, 50176
    s_nop 0
    buffer_load_dwordx4 v253, s[16:19], s68 offen lds
    v_mfma_f32_16x16x32_bf16 v[56:59], v[88:91], v[140:143], v[56:59]
    ds_read_b64_tr_b16 v[74:75], v215 offset:23552
    s_add_u32 m0, s64, 51200
    s_waitcnt lgkmcnt(6)
    v_mfma_f32_16x16x32_bf16 v[44:47], v[92:95], v[136:139], v[44:47]
    ds_read_b64_tr_b16 v[76:77], v216 offset:21504
    s_mov_b64 exec, s[66:67]
    buffer_load_dwordx4 v254, s[16:19], s68 offen lds
    s_mov_b64 exec, -1
    s_mov_b32 s68, 917504
    v_mfma_f32_16x16x32_bf16 v[60:63], v[92:95], v[140:143], v[60:63]
    ds_read_b64_tr_b16 v[78:79], v216 offset:23552
    s_add_u32 m0, s64, 57344
    s_nop 0
    buffer_load_dwordx4 v253, s[16:19], s68 offen lds
    s_waitcnt vmcnt(8) lgkmcnt(6)
    v_mfma_f32_16x16x32_bf16 v[32:35], v[64:67], v[144:147], v[32:35]
    s_barrier
    s_waitcnt vmcnt(7)
    v_mfma_f32_16x16x32_bf16 v[48:51], v[64:67], v[148:151], v[48:51]
    ds_read_b64_tr_b16 v[80:81], v215 offset:25088
    s_add_u32 m0, s64, 58368
    s_waitcnt lgkmcnt(5)
    v_mfma_f32_16x16x32_bf16 v[36:39], v[68:71], v[144:147], v[36:39]
    ds_read_b64_tr_b16 v[82:83], v215 offset:27136
    s_mov_b64 exec, s[66:67]
    buffer_load_dwordx4 v254, s[16:19], s68 offen lds
    s_mov_b64 exec, -1
    s_mov_b32 s68, 1032192
    v_mfma_f32_16x16x32_bf16 v[52:55], v[68:71], v[148:151], v[52:55]
    ds_read_b64_tr_b16 v[84:85], v216 offset:25088
    s_add_u32 m0, s64, 64512
    s_nop 0
    buffer_load_dwordx4 v253, s[16:19], s68 offen lds
    s_waitcnt lgkmcnt(5)
    v_mfma_f32_16x16x32_bf16 v[40:43], v[72:75], v[144:147], v[40:43]
    ds_read_b64_tr_b16 v[86:87], v216 offset:27136
    s_add_u32 m0, s64, 65536
    s_mov_b64 exec, s[66:67]
    buffer_load_dwordx4 v254, s[16:19], s68 offen lds
    s_mov_b64 exec, -1
    v_mfma_f32_16x16x32_bf16 v[56:59], v[72:75], v[148:151], v[56:59]
    ds_read_b64_tr_b16 v[88:89], v213 offset:25088
    s_mov_b32 s68, 1146880
    s_add_u32 m0, s64, 71680
    s_waitcnt lgkmcnt(5)
    v_mfma_f32_16x16x32_bf16 v[44:47], v[76:79], v[144:147], v[44:47]
    ds_read_b64_tr_b16 v[90:91], v213 offset:27136
    buffer_load_dwordx4 v253, s[16:19], s68 offen lds
    s_add_u32 m0, s64, 72704
    v_mfma_f32_16x16x32_bf16 v[60:63], v[76:79], v[148:151], v[60:63]
    ds_read_b64_tr_b16 v[92:93], v214 offset:25088
    ds_read_b64_tr_b16 v[94:95], v214 offset:27136
    s_mov_b64 exec, s[66:67]
    buffer_load_dwordx4 v254, s[16:19], s68 offen lds
    s_mov_b64 exec, -1
    s_mov_b32 s68, 1261568
    s_waitcnt vmcnt(10) lgkmcnt(6)
    v_mfma_f32_16x16x32_bf16 v[48:51], v[80:83], v[156:159], v[48:51]
    s_add_u32 m0, s64, 78848
    s_waitcnt lgkmcnt(4)
    v_mfma_f32_16x16x32_bf16 v[52:55], v[84:87], v[156:159], v[52:55]
    buffer_load_dwordx4 v253, s[16:19], s68 offen lds
    s_add_u32 m0, s64, 79872
    s_waitcnt lgkmcnt(2)
    v_mfma_f32_16x16x32_bf16 v[56:59], v[88:91], v[156:159], v[56:59]
    s_mov_b64 exec, s[66:67]
    buffer_load_dwordx4 v254, s[16:19], s68 offen lds
    s_mov_b64 exec, -1
    s_mov_b32 s68, 1376256
    s_waitcnt lgkmcnt(0)
    v_mfma_f32_16x16x32_bf16 v[60:63], v[92:95], v[156:159], v[60:63]
    s_add_u32 m0, s64, 86016
    s_nop 0
    buffer_load_dwordx4 v253, s[16:19], s68 offen lds
    v_mfma_f32_16x16x32_bf16 v[32:35], v[80:83], v[152:155], v[32:35]
    s_add_u32 m0, s64, 87040
    v_mfma_f32_16x16x32_bf16 v[36:39], v[84:87], v[152:155], v[36:39]
    s_mov_b64 exec, s[66:67]
    buffer_load_dwordx4 v254, s[16:19], s68 offen lds
    s_mov_b64 exec, -1
    s_mov_b32 s68, 1490944
    v_mfma_f32_16x16x32_bf16 v[40:43], v[88:91], v[152:155], v[40:43]
    s_add_u32 m0, s64, 93184
    s_nop 0
    buffer_load_dwordx4 v253, s[16:19], s68 offen lds
    v_mfma_f32_16x16x32_bf16 v[44:47], v[92:95], v[152:155], v[44:47]
    s_add_u32 m0, s64, 94208
    s_mov_b64 exec, s[66:67]
    buffer_load_dwordx4 v254, s[16:19], s68 offen lds
    s_mov_b64 exec, -1
    ds_write_b128 v220, v[48:51] offset:0
    ds_write_b128 v220, v[52:55] offset:1024
    ds_write_b128 v220, v[56:59] offset:2048
    ds_write_b128 v220, v[60:63] offset:3072
    s_waitcnt lgkmcnt(0)
    s_barrier
    ds_read_b128 v[176:179], v221 offset:0
    ds_read_b128 v[180:183], v221 offset:1024
    ds_read_b128 v[184:187], v221 offset:2048
    ds_read_b128 v[188:191], v221 offset:3072
    s_waitcnt lgkmcnt(3)
    v_pk_add_f32 v[32:33], v[32:33], v[176:177]
    v_pk_add_f32 v[34:35], v[34:35], v[178:179]
    v_pk_add_f32 v[32:33], v[32:33], v[192:193]
    v_pk_add_f32 v[34:35], v[34:35], v[194:195]
    s_waitcnt lgkmcnt(2)
    v_pk_add_f32 v[36:37], v[36:37], v[180:181]
    v_pk_add_f32 v[38:39], v[38:39], v[182:183]
    v_pk_add_f32 v[36:37], v[36:37], v[196:197]
    v_pk_add_f32 v[38:39], v[38:39], v[198:199]
    s_waitcnt lgkmcnt(1)
    v_pk_add_f32 v[40:41], v[40:41], v[184:185]
    v_pk_add_f32 v[42:43], v[42:43], v[186:187]
    v_pk_add_f32 v[40:41], v[40:41], v[200:201]
    v_pk_add_f32 v[42:43], v[42:43], v[202:203]
    s_waitcnt lgkmcnt(0)
    v_pk_add_f32 v[44:45], v[44:45], v[188:189]
    v_pk_add_f32 v[46:47], v[46:47], v[190:191]
    v_pk_add_f32 v[44:45], v[44:45], v[204:205]
    v_pk_add_f32 v[46:47], v[46:47], v[206:207]
    v_cvt_pk_bf16_f32 v208, v32, v33
    v_cvt_pk_bf16_f32 v209, v34, v35
    v_cvt_pk_bf16_f32 v210, v36, v37
    v_cvt_pk_bf16_f32 v211, v38, v39
    buffer_store_dwordx4 v[208:211], v223, s[28:31], 0 offen offset:0 sc1
    v_cvt_pk_bf16_f32 v212, v40, v41
    v_cvt_pk_bf16_f32 v213, v42, v43
    v_cvt_pk_bf16_f32 v214, v44, v45
    v_cvt_pk_bf16_f32 v215, v46, v47
    buffer_store_dwordx4 v[212:215], v223, s[28:31], 0 offen offset:1024 sc1
    v_pk_mul_f32 v[170:171], v[32:33], v[32:33]
    v_pk_add_f32 v[168:169], v[32:33], v[34:35]
    v_pk_fma_f32 v[170:171], v[34:35], v[34:35], v[170:171]
    v_pk_add_f32 v[168:169], v[168:169], v[36:37]
    v_pk_fma_f32 v[170:171], v[36:37], v[36:37], v[170:171]
    v_pk_add_f32 v[168:169], v[168:169], v[38:39]
    v_pk_fma_f32 v[170:171], v[38:39], v[38:39], v[170:171]
    v_pk_add_f32 v[168:169], v[168:169], v[40:41]
    v_pk_fma_f32 v[170:171], v[40:41], v[40:41], v[170:171]
    v_pk_add_f32 v[168:169], v[168:169], v[42:43]
    v_pk_fma_f32 v[170:171], v[42:43], v[42:43], v[170:171]
    v_pk_add_f32 v[168:169], v[168:169], v[44:45]
    v_pk_fma_f32 v[170:171], v[44:45], v[44:45], v[170:171]
    v_pk_add_f32 v[168:169], v[168:169], v[46:47]
    v_pk_fma_f32 v[170:171], v[46:47], v[46:47], v[170:171]
    v_add_f32 v168, v168, v169
    v_add_f32 v169, v170, v171
    v_mov_b32 v170, v168
    v_mov_b32 v171, v169
    s_nop 0
    v_permlane32_swap_b32 v168, v170
    s_nop 0
    v_permlane32_swap_b32 v169, v171
    v_add_f32 v168, v168, v170
    v_add_f32 v169, v169, v171
    v_mov_b32 v170, v168
    v_mov_b32 v171, v169
    s_nop 0
    v_permlane16_swap_b32 v168, v170
    s_nop 0
    v_permlane16_swap_b32 v169, v171
    v_add_f32 v168, v168, v170
    v_add_f32 v169, v169, v171
    buffer_store_dwordx2 v[168:169], v219, s[28:31], 0 offen sc1
    s_waitcnt vmcnt(0)
    s_cmp_eq_u32 s37, 1
    s_cbranch_scc0 L_slow_h
    s_lshl_b32 s40, s32, 12
    s_lshl_b32 s41, s33, 4
    s_add_u32 s40, s40, s41
    s_lshl_b32 s41, s34, 2
    s_add_u32 s40, s40, s41
    s_add_u32 s40, s40, 2048
    v_mov_b32 v20, s35
    s_mov_b64 exec, 1
    buffer_store_dword v20, off, s[28:31], s40
    s_mov_b64 exec, -1
    s_branch L_join_h
L_slow_h:
    s_lshl_b32 s40, s32, 12
    s_lshl_b32 s41, s33, 4
    s_add_u32 s40, s40, s41
    s_lshl_b32 s41, s34, 2
    s_add_u32 s40, s40, s41
    s_add_u32 s40, s40, 2048
    v_mov_b32 v20, s35
    s_mov_b64 exec, 1
    buffer_store_dword v20, off, s[28:31], s40 sc1
    s_mov_b64 exec, -1
L_join_h:
    s_barrier
    s_lshl_b32 s68, s32, 12
    s_add_u32 s68, s68, 2048
    v_lshl_add_u32 v9, v0, 2, s68
    buffer_load_dword v10, v9, s[28:31], 0 offen sc1
    s_branch L_preC
L_skipB:
    s_barrier
    s_mov_b32 s68, 688128
    s_add_u32 m0, s64, 43008
    s_nop 0
    buffer_load_dwordx4 v253, s[16:19], s68 offen lds
    s_add_u32 m0, s64, 44032
    s_mov_b64 exec, s[66:67]
    buffer_load_dwordx4 v254, s[16:19], s68 offen lds
    s_mov_b64 exec, -1
    s_mov_b32 s68, 802816
    s_add_u32 m0, s64, 50176
    s_nop 0
    buffer_load_dwordx4 v253, s[16:19], s68 offen lds
    s_add_u32 m0, s64, 51200
    s_mov_b64 exec, s[66:67]
    buffer_load_dwordx4 v254, s[16:19], s68 offen lds
    s_mov_b64 exec, -1
    s_mov_b32 s68, 917504
    s_add_u32 m0, s64, 57344
    s_nop 0
    buffer_load_dwordx4 v253, s[16:19], s68 offen lds
    s_add_u32 m0, s64, 58368
    s_mov_b64 exec, s[66:67]
    buffer_load_dwordx4 v254, s[16:19], s68 offen lds
    s_mov_b64 exec, -1
    s_mov_b32 s68, 1032192
    s_add_u32 m0, s64, 64512
    s_nop 0
    buffer_load_dwordx4 v253, s[16:19], s68 offen lds
    s_add_u32 m0, s64, 65536
    s_mov_b64 exec, s[66:67]
    buffer_load_dwordx4 v254, s[16:19], s68 offen lds
    s_mov_b64 exec, -1
    s_mov_b32 s68, 1146880
    s_add_u32 m0, s64, 71680
    s_nop 0
    buffer_load_dwordx4 v253, s[16:19], s68 offen lds
    s_add_u32 m0, s64, 72704
    s_mov_b64 exec, s[66:67]
    buffer_load_dwordx4 v254, s[16:19], s68 offen lds
    s_mov_b64 exec, -1
    s_mov_b32 s68, 1261568
    s_add_u32 m0, s64, 78848
    s_nop 0
    buffer_load_dwordx4 v253, s[16:19], s68 offen lds
    s_add_u32 m0, s64, 79872
    s_mov_b64 exec, s[66:67]
    buffer_load_dwordx4 v254, s[16:19], s68 offen lds
    s_mov_b64 exec, -1
    s_mov_b32 s68, 1376256
    s_add_u32 m0, s64, 86016
    s_nop 0
    buffer_load_dwordx4 v253, s[16:19], s68 offen lds
    s_add_u32 m0, s64, 87040
    s_mov_b64 exec, s[66:67]
    buffer_load_dwordx4 v254, s[16:19], s68 offen lds
    s_mov_b64 exec, -1
    s_mov_b32 s68, 1490944
    s_add_u32 m0, s64, 93184
    s_nop 0
    buffer_load_dwordx4 v253, s[16:19], s68 offen lds
    s_add_u32 m0, s64, 94208
    s_mov_b64 exec, s[66:67]
    buffer_load_dwordx4 v254, s[16:19], s68 offen lds
    s_mov_b64 exec, -1
    s_waitcnt vmcnt(0)
    s_barrier
    s_lshl_b32 s68, s32, 12
    s_add_u32 s68, s68, 2048
    v_lshl_add_u32 v9, v0, 2, s68
    buffer_load_dword v10, v9, s[28:31], 0 offen sc1
L_preC:
    v_add_u32 v23, 50176, v243
    v_add_u32 v16, 50176, v244
    v_mov_b32 v40, 0x3f803f80
    v_mov_b32 v41, 0x3f803f80
    v_mov_b32 v42, 0x3f803f80
    v_mov_b32 v43, 0x3f803f80
    ds_read_b64_tr_b16 v[144:145], v243 offset:0
    ds_read_b64_tr_b16 v[146:147], v243 offset:3584
    ds_read_b64_tr_b16 v[148:149], v244 offset:0
    ds_read_b64_tr_b16 v[150:151], v244 offset:3584
    ds_read_b64_tr_b16 v[152:153], v243 offset:7168
    ds_read_b64_tr_b16 v[154:155], v243 offset:10752
    ds_read_b64_tr_b16 v[156:157], v244 offset:7168
    ds_read_b64_tr_b16 v[158:159], v244 offset:10752
    ds_read_b64_tr_b16 v[160:161], v243 offset:14336
    ds_read_b64_tr_b16 v[162:163], v243 offset:17920
    ds_read_b64_tr_b16 v[164:165], v244 offset:14336
    ds_read_b64_tr_b16 v[166:167], v244 offset:17920
    s_waitcnt lgkmcnt(10)
    v_mfma_f32_16x16x32_bf16 v[32:35], v[144:147], v[40:43], 0
    ds_read_b64_tr_b16 v[168:169], v243 offset:21504
    ds_read_b64_tr_b16 v[170:171], v243 offset:25088
    s_add_u32 s68, s65, 0
    s_waitcnt lgkmcnt(10)
    v_mfma_f32_16x16x32_bf16 v[36:39], v[148:151], v[40:43], 0
    ds_read_b64_tr_b16 v[172:173], v244 offset:21504
    ds_read_b64_tr_b16 v[174:175], v244 offset:25088
    s_add_u32 m0, s62, 102400
    s_nop 0
    buffer_load_dwordx4 v255, s[20:23], s68 offen lds
    s_waitcnt lgkmcnt(10)
    v_mfma_f32_16x16x32_bf16 v[32:35], v[152:155], v[40:43], v[32:35]
    ds_read_b64_tr_b16 v[176:177], v243 offset:28672
    ds_read_b64_tr_b16 v[178:179], v243 offset:32256
    s_add_u32 s68, s65, 802816
    s_waitcnt lgkmcnt(10)
    v_mfma_f32_16x16x32_bf16 v[36:39], v[156:159], v[40:43], v[36:39]
    ds_read_b64_tr_b16 v[180:181], v244 offset:28672
    ds_read_b64_tr_b16 v[182:183], v244 offset:32256
    s_add_u32 m0, s62, 131072
    s_nop 0
    buffer_load_dwordx4 v255, s[20:23], s68 offen lds
    s_waitcnt lgkmcnt(10)
    v_mfma_f32_16x16x32_bf16 v[32:35], v[160:163], v[40:43], v[32:35]
    ds_read_b64_tr_b16 v[144:145], v243 offset:35840
    ds_read_b64_tr_b16 v[146:147], v243 offset:39424
    s_add_u32 s68, s65, 28672
    s_waitcnt lgkmcnt(10)
    v_mfma_f32_16x16x32_bf16 v[36:39], v[164:167], v[40:43], v[36:39]
    ds_read_b64_tr_b16 v[148:149], v244 offset:35840
    ds_read_b64_tr_b16 v[150:151], v244 offset:39424
    s_add_u32 m0, s62, 106496
    s_nop 0
    buffer_load_dwordx4 v255, s[20:23], s68 offen lds
    s_waitcnt lgkmcnt(10)
    v_mfma_f32_16x16x32_bf16 v[32:35], v[168:171], v[40:43], v[32:35]
    ds_read_b64_tr_b16 v[152:153], v243 offset:43008
    ds_read_b64_tr_b16 v[154:155], v243 offset:46592
    s_add_u32 s68, s65, 831488
    s_waitcnt lgkmcnt(10)
    v_mfma_f32_16x16x32_bf16 v[36:39], v[172:175], v[40:43], v[36:39]
    ds_read_b64_tr_b16 v[156:157], v244 offset:43008
    ds_read_b64_tr_b16 v[158:159], v244 offset:46592
    s_add_u32 m0, s62, 135168
    s_nop 0
    buffer_load_dwordx4 v255, s[20:23], s68 offen lds
    s_waitcnt lgkmcnt(10)
    v_mfma_f32_16x16x32_bf16 v[32:35], v[176:179], v[40:43], v[32:35]
    ds_read_b64_tr_b16 v[160:161], v23 offset:0
    ds_read_b64_tr_b16 v[162:163], v23 offset:3584
    s_add_u32 s68, s65, 57344
    s_waitcnt lgkmcnt(10)
    v_mfma_f32_16x16x32_bf16 v[36:39], v[180:183], v[40:43], v[36:39]
    ds_read_b64_tr_b16 v[164:165], v16 offset:0
    ds_read_b64_tr_b16 v[166:167], v16 offset:3584
    s_add_u32 m0, s62, 110592
    s_nop 0
    buffer_load_dwordx4 v255, s[20:23], s68 offen lds
    s_waitcnt lgkmcnt(10)
    v_mfma_f32_16x16x32_bf16 v[32:35], v[144:147], v[40:43], v[32:35]
    ds_read_b64_tr_b16 v[168:169], v23 offset:7168
    ds_read_b64_tr_b16 v[170:171], v23 offset:10752
    s_add_u32 s68, s65, 860160
    s_waitcnt lgkmcnt(10)
    v_mfma_f32_16x16x32_bf16 v[36:39], v[148:151], v[40:43], v[36:39]
    ds_read_b64_tr_b16 v[172:173], v16 offset:7168
    ds_read_b64_tr_b16 v[174:175], v16 offset:10752
    s_add_u32 m0, s62, 139264
    s_nop 0
    buffer_load_dwordx4 v255, s[20:23], s68 offen lds
    s_waitcnt lgkmcnt(10)
    v_mfma_f32_16x16x32_bf16 v[32:35], v[152:155], v[40:43], v[32:35]
    ds_read_b64_tr_b16 v[176:177], v23 offset:14336
    ds_read_b64_tr_b16 v[178:179], v23 offset:17920
    s_add_u32 s68, s65, 86016
    s_waitcnt lgkmcnt(10)
    v_mfma_f32_16x16x32_bf16 v[36:39], v[156:159], v[40:43], v[36:39]
    ds_read_b64_tr_b16 v[180:181], v16 offset:14336
    ds_read_b64_tr_b16 v[182:183], v16 offset:17920
    s_add_u32 m0, s62, 114688
    s_nop 0
    buffer_load_dwordx4 v255, s[20:23], s68 offen lds
    s_waitcnt lgkmcnt(10)
    v_mfma_f32_16x16x32_bf16 v[32:35], v[160:163], v[40:43], v[32:35]
    ds_read_b64_tr_b16 v[144:145], v23 offset:21504
    ds_read_b64_tr_b16 v[146:147], v23 offset:25088
    s_add_u32 s68, s65, 888832
    s_add_u32 m0, s62, 143360
    s_waitcnt lgkmcnt(10)
    v_mfma_f32_16x16x32_bf16 v[36:39], v[164:167], v[40:43], v[36:39]
    ds_read_b64_tr_b16 v[148:149], v16 offset:21504
    ds_read_b64_tr_b16 v[150:151], v16 offset:25088
    buffer_load_dwordx4 v255, s[20:23], s68 offen lds
    s_waitcnt lgkmcnt(10)
    v_mfma_f32_16x16x32_bf16 v[32:35], v[168:171], v[40:43], v[32:35]
    ds_read_b64_tr_b16 v[152:153], v23 offset:28672
    ds_read_b64_tr_b16 v[154:155], v23 offset:32256
    s_add_u32 s68, s65, 114688
    s_add_u32 m0, s62, 118784
    s_waitcnt lgkmcnt(10)
    v_mfma_f32_16x16x32_bf16 v[36:39], v[172:175], v[40:43], v[36:39]
    ds_read_b64_tr_b16 v[156:157], v16 offset:28672
    ds_read_b64_tr_b16 v[158:159], v16 offset:32256
    buffer_load_dwordx4 v255, s[20:23], s68 offen lds
    s_waitcnt lgkmcnt(10)
    v_mfma_f32_16x16x32_bf16 v[32:35], v[176:179], v[40:43], v[32:35]
    ds_read_b64_tr_b16 v[160:161], v23 offset:35840
    ds_read_b64_tr_b16 v[162:163], v23 offset:39424
    buffer_load_dword v11, v9, s[28:31], 0 offen sc1
    s_add_u32 s68, s65, 917504
    s_waitcnt lgkmcnt(10)
    v_mfma_f32_16x16x32_bf16 v[36:39], v[180:183], v[40:43], v[36:39]
    ds_read_b64_tr_b16 v[164:165], v16 offset:35840
    ds_read_b64_tr_b16 v[166:167], v16 offset:39424
    s_add_u32 m0, s62, 147456
    s_waitcnt lgkmcnt(10)
    v_mfma_f32_16x16x32_bf16 v[32:35], v[144:147], v[40:43], v[32:35]
    ds_read_b64_tr_b16 v[168:169], v23 offset:43008
    ds_read_b64_tr_b16 v[170:171], v23 offset:46592
    buffer_load_dwordx4 v255, s[20:23], s68 offen lds
    s_add_u32 s68, s65, 143360
    s_waitcnt lgkmcnt(10)
    v_mfma_f32_16x16x32_bf16 v[36:39], v[148:151], v[40:43], v[36:39]
    ds_read_b64_tr_b16 v[172:173], v16 offset:43008
    ds_read_b64_tr_b16 v[174:175], v16 offset:46592
    s_add_u32 m0, s62, 122880
    s_waitcnt lgkmcnt(10)
    v_mfma_f32_16x16x32_bf16 v[32:35], v[152:155], v[40:43], v[32:35]
    buffer_load_dwordx4 v255, s[20:23], s68 offen lds
    s_add_u32 s68, s65, 946176
    s_waitcnt lgkmcnt(8)
    v_mfma_f32_16x16x32_bf16 v[36:39], v[156:159], v[40:43], v[36:39]
    s_add_u32 m0, s62, 151552
    s_waitcnt lgkmcnt(6)
    v_mfma_f32_16x16x32_bf16 v[32:35], v[160:163], v[40:43], v[32:35]
    buffer_load_dwordx4 v255, s[20:23], s68 offen lds
    s_add_u32 s68, s65, 172032
    s_waitcnt lgkmcnt(4)
    v_mfma_f32_16x16x32_bf16 v[36:39], v[164:167], v[40:43], v[36:39]
    s_add_u32 m0, s62, 126976
    s_waitcnt lgkmcnt(2)
    v_mfma_f32_16x16x32_bf16 v[32:35], v[168:171], v[40:43], v[32:35]
    buffer_load_dwordx4 v255, s[20:23], s68 offen lds
    s_add_u32 s68, s65, 974848
    s_waitcnt lgkmcnt(0)
    v_mfma_f32_16x16x32_bf16 v[36:39], v[172:175], v[40:43], v[36:39]
    s_add_u32 m0, s62, 155648
    s_nop 0
    buffer_load_dwordx4 v255, s[20:23], s68 offen lds
    s_mov_b32 exec_lo, 0x00010001
    s_mov_b32 exec_hi, 0x00010001
    ds_write_b128 v245, v[32:35]
    s_nop 2
    ds_write_b128 v246, v[36:39]
    s_mov_b64 exec, -1
    v_mov_b32 v12, v250
    v_xor_b32 v13, 64, v250
    s_mov_b32 s44, 0xffffffff
    s_mov_b32 s45, 0xffffff
    s_waitcnt vmcnt(15)
    v_cmp_eq_u32 vcc, s35, v10
    s_nop 0
    s_and_b64 vcc, vcc, s[44:45]
    s_cmp_eq_u64 vcc, s[44:45]
    s_cbranch_scc1 L_pollok_f2
    s_waitcnt vmcnt(5)
    v_cmp_eq_u32 vcc, s35, v11
    s_nop 0
    s_and_b64 vcc, vcc, s[44:45]
    s_cmp_eq_u64 vcc, s[44:45]
    s_cbranch_scc1 L_pollok_f2
    s_mov_b32 s42, 0
    buffer_load_dword v20, v9, s[28:31], 0 offen sc1
    buffer_load_dword v21, v9, s[28:31], 0 offen sc1
L_poll_f2:
    buffer_load_dword v22, v9, s[28:31], 0 offen sc1
    s_waitcnt vmcnt(2)
    v_cmp_eq_u32 vcc, s35, v20
    s_nop 0
    s_and_b64 vcc, vcc, s[44:45]
    s_cmp_eq_u64 vcc, s[44:45]
    s_cbranch_scc1 L_pollok_f2
    buffer_load_dword v20, v9, s[28:31], 0 offen sc1
    s_waitcnt vmcnt(2)
    v_cmp_eq_u32 vcc, s35, v21
    s_nop 0
    s_and_b64 vcc, vcc, s[44:45]
    s_cmp_eq_u64 vcc, s[44:45]
    s_cbranch_scc1 L_pollok_f2
    buffer_load_dword v21, v9, s[28:31], 0 offen sc1
    s_waitcnt vmcnt(2)
    v_cmp_eq_u32 vcc, s35, v22
    s_nop 0
    s_and_b64 vcc, vcc, s[44:45]
    s_cmp_eq_u64 vcc, s[44:45]
    s_cbranch_scc1 L_pollok_f2
    s_add_u32 s42, s42, 1
    s_cmp_lt_u32 s42, 0x40000
    s_cbranch_scc1 L_poll_f2
L_pollok_f2:
    s_movk_i32 s69, 4096
    buffer_load_dwordx2 v[24:25], v242, s[28:31], 0 offen offset:0 sc1
    buffer_load_dwordx2 v[26:27], v242, s[28:31], s69 offen offset:0 sc1
    buffer_load_dwordx2 v[28:29], v242, s[28:31], 0 offen offset:128 sc1
    buffer_load_dwordx2 v[30:31], v242, s[28:31], s69 offen offset:128 sc1
    buffer_load_dwordx4 a[128:131], v241, s[28:31], 0 offen offset:0 sc1
    s_mov_b32 s69, 14336
    buffer_load_dwordx4 a[132:135], v241, s[28:31], s69 offen offset:0 sc1
    s_waitcnt vmcnt(8)
    s_waitcnt lgkmcnt(0)
    s_barrier
    ds_read_b128 v[172:175], v247 offset:0
    ds_read_b128 v[176:179], v247 offset:64
    ds_read_b128 v[180:183], v247 offset:128
    ds_read_b128 v[184:187], v247 offset:192
    ds_read_b128 v[188:191], v247 offset:256
    ds_read_b128 v[192:195], v247 offset:320
    ds_read_b128 v[196:199], v247 offset:384
    buffer_load_dwordx4 a[136:139], v241, s[28:31], 0 offen offset:1024 sc1
    s_mov_b32 s69, 14336
    buffer_load_dwordx4 a[140:143], v241, s[28:31], s69 offen offset:1024 sc1
    ds_read_b64_tr_b16 a[0:1], v12 offset:0
    ds_read_b64_tr_b16 a[2:3], v12 offset:512
    ds_read_b64_tr_b16 a[4:5], v13 offset:0
    ds_read_b64_tr_b16 a[6:7], v13 offset:512
    ds_read_b64_tr_b16 a[8:9], v12 offset:2048
    ds_read_b64_tr_b16 a[10:11], v12 offset:2560
    ds_read_b64_tr_b16 a[12:13], v13 offset:2048
    ds_read_b64_tr_b16 a[14:15], v13 offset:2560
    buffer_load_dwordx4 a[144:147], v241, s[28:31], 0 offen offset:2048 sc1
    s_mov_b32 s69, 14336
    buffer_load_dwordx4 a[148:151], v241, s[28:31], s69 offen offset:2048 sc1
    ds_read_b64_tr_b16 a[16:17], v12 offset:4096
    ds_read_b64_tr_b16 a[18:19], v12 offset:4608
    ds_read_b64_tr_b16 a[20:21], v13 offset:4096
    ds_read_b64_tr_b16 a[22:23], v13 offset:4608
    ds_read_b64_tr_b16 a[24:25], v12 offset:6144
    ds_read_b64_tr_b16 a[26:27], v12 offset:6656
    ds_read_b64_tr_b16 a[28:29], v13 offset:6144
    ds_read_b64_tr_b16 a[30:31], v13 offset:6656
    buffer_load_dwordx4 a[152:155], v241, s[28:31], 0 offen offset:3072 sc1
    s_mov_b32 s69, 14336
    buffer_load_dwordx4 a[156:159], v241, s[28:31], s69 offen offset:3072 sc1
    ds_read_b64_tr_b16 a[32:33], v12 offset:8192
    ds_read_b64_tr_b16 a[34:35], v12 offset:8704
    ds_read_b64_tr_b16 a[36:37], v13 offset:8192
    ds_read_b64_tr_b16 a[38:39], v13 offset:8704
    ds_read_b64_tr_b16 a[40:41], v12 offset:10240
    ds_read_b64_tr_b16 a[42:43], v12 offset:10752
    ds_read_b64_tr_b16 a[44:45], v13 offset:10240
    ds_read_b64_tr_b16 a[46:47], v13 offset:10752
    s_mov_b32 s69, 4096
    buffer_load_dwordx4 a[160:163], v241, s[28:31], s69 offen offset:0 sc1
    s_mov_b32 s69, 18432
    buffer_load_dwordx4 a[164:167], v241, s[28:31], s69 offen offset:0 sc1
    ds_read_b64_tr_b16 a[48:49], v12 offset:12288
    ds_read_b64_tr_b16 a[50:51], v12 offset:12800
    ds_read_b64_tr_b16 a[52:53], v13 offset:12288
    ds_read_b64_tr_b16 a[54:55], v13 offset:12800
    ds_read_b64_tr_b16 a[56:57], v12 offset:14336
    ds_read_b64_tr_b16 a[58:59], v12 offset:14848
    ds_read_b64_tr_b16 a[60:61], v13 offset:14336
    ds_read_b64_tr_b16 a[62:63], v13 offset:14848
    s_mov_b32 s69, 4096
    buffer_load_dwordx4 a[168:171], v241, s[28:31], s69 offen offset:1024 sc1
    s_mov_b32 s69, 18432
    buffer_load_dwordx4 a[172:175], v241, s[28:31], s69 offen offset:1024 sc1
    ds_read_b64_tr_b16 a[64:65], v12 offset:16384
    ds_read_b64_tr_b16 a[66:67], v12 offset:16896
    ds_read_b64_tr_b16 a[68:69], v13 offset:16384
    ds_read_b64_tr_b16 a[70:71], v13 offset:16896
    ds_read_b64_tr_b16 a[72:73], v12 offset:18432
    ds_read_b64_tr_b16 a[74:75], v12 offset:18944
    ds_read_b64_tr_b16 a[76:77], v13 offset:18432
    ds_read_b64_tr_b16 a[78:79], v13 offset:18944
    s_mov_b32 s69, 4096
    buffer_load_dwordx4 a[176:179], v241, s[28:31], s69 offen offset:2048 sc1
    s_mov_b32 s69, 18432
    buffer_load_dwordx4 a[180:183], v241, s[28:31], s69 offen offset:2048 sc1
    ds_read_b64_tr_b16 a[80:81], v12 offset:20480
    ds_read_b64_tr_b16 a[82:83], v12 offset:20992
    ds_read_b64_tr_b16 a[84:85], v13 offset:20480
    ds_read_b64_tr_b16 a[86:87], v13 offset:20992
    ds_read_b64_tr_b16 a[88:89], v12 offset:22528
    ds_read_b64_tr_b16 a[90:91], v12 offset:23040
    ds_read_b64_tr_b16 a[92:93], v13 offset:22528
    ds_read_b64_tr_b16 a[94:95], v13 offset:23040
    s_mov_b32 s69, 4096
    buffer_load_dwordx4 a[184:187], v241, s[28:31], s69 offen offset:3072 sc1
    s_mov_b32 s69, 18432
    buffer_load_dwordx4 a[188:191], v241, s[28:31], s69 offen offset:3072 sc1
    ds_read_b64_tr_b16 a[96:97], v12 offset:24576
    ds_read_b64_tr_b16 a[98:99], v12 offset:25088
    ds_read_b64_tr_b16 a[100:101], v13 offset:24576
    ds_read_b64_tr_b16 a[102:103], v13 offset:25088
    ds_read_b64_tr_b16 a[104:105], v12 offset:26624
    ds_read_b64_tr_b16 a[106:107], v12 offset:27136
    ds_read_b64_tr_b16 a[108:109], v13 offset:26624
    ds_read_b64_tr_b16 a[110:111], v13 offset:27136
    s_waitcnt lgkmcnt(0)
    ds_read_b64_tr_b16 v[88:89], v239 offset:0
    ds_read_b64_tr_b16 v[90:91], v239 offset:3584
    ds_read_b64_tr_b16 v[92:93], v239 offset:32
    ds_read_b64_tr_b16 v[94:95], v239 offset:3616
    ds_read_b64_tr_b16 v[96:97], v239 offset:64
    ds_read_b64_tr_b16 v[98:99], v239 offset:3648
    ds_read_b64_tr_b16 v[100:101], v239 offset:96
    ds_read_b64_tr_b16 v[102:103], v239 offset:3680
    ds_read_b64_tr_b16 v[104:105], v239 offset:7168
    ds_read_b64_tr_b16 v[106:107], v239 offset:10752
    ds_read_b64_tr_b16 v[108:109], v239 offset:7200
    ds_read_b64_tr_b16 v[110:111], v239 offset:10784
    ds_read_b64_tr_b16 v[112:113], v239 offset:7232
    ds_read_b64_tr_b16 v[114:115], v239 offset:10816
    ds_read_b64_tr_b16 v[116:117], v239 offset:7264
    ds_read_b64_tr_b16 v[118:119], v239 offset:10848
    s_barrier
    s_waitcnt vmcnt(15) lgkmcnt(14)
    v_mfma_f32_16x16x32_bf16 v[32:35], v[88:91], a[128:131], 0
    ds_read_b64_tr_b16 v[120:121], v239 offset:14336
    s_mov_b32 s69, 8192
    s_waitcnt vmcnt(14)
    v_mfma_f32_16x16x32_bf16 v[60:63], v[88:91], a[132:135], 0
    ds_read_b64_tr_b16 v[122:123], v239 offset:17920
    buffer_load_dwordx4 a[192:195], v241, s[28:31], s69 offen offset:0 sc1
    s_waitcnt lgkmcnt(14)
    v_mfma_f32_16x16x32_bf16 v[36:39], v[92:95], a[128:131], 0
    ds_read_b64_tr_b16 v[124:125], v239 offset:14368
    s_mov_b32 s69, 22528
    v_mfma_f32_16x16x32_bf16 v[64:67], v[92:95], a[132:135], 0
    ds_read_b64_tr_b16 v[126:127], v239 offset:17952
    buffer_load_dwordx4 a[196:199], v241, s[28:31], s69 offen offset:0 sc1
    s_waitcnt lgkmcnt(14)
    v_mfma_f32_16x16x32_bf16 v[40:43], v[96:99], a[128:131], 0
    ds_read_b64_tr_b16 v[128:129], v239 offset:14400
    s_add_u32 s68, s65, 200704
    v_mfma_f32_16x16x32_bf16 v[68:71], v[96:99], a[132:135], 0
    ds_read_b64_tr_b16 v[130:131], v239 offset:17984
    s_add_u32 m0, s62, 155648
    s_waitcnt lgkmcnt(14)
    v_mfma_f32_16x16x32_bf16 v[44:47], v[100:103], a[128:131], 0
    ds_read_b64_tr_b16 v[132:133], v239 offset:14432
    buffer_load_dwordx4 v255, s[20:23], s68 offen lds
    v_mfma_f32_16x16x32_bf16 v[72:75], v[100:103], a[132:135], 0
    ds_read_b64_tr_b16 v[134:135], v239 offset:18016
    s_add_u32 s68, s65, 1003520
    s_waitcnt vmcnt(16) lgkmcnt(14)
    v_mfma_f32_16x16x32_bf16 v[32:35], v[104:107], a[136:139], v[32:35]
    ds_read_b64_tr_b16 v[88:89], v239 offset:21504
    s_mov_b32 s69, 8192
    s_waitcnt vmcnt(15)
    v_mfma_f32_16x16x32_bf16 v[60:63], v[104:107], a[140:143], v[60:63]
    ds_read_b64_tr_b16 v[90:91], v239 offset:25088
    buffer_load_dwordx4 a[200:203], v241, s[28:31], s69 offen offset:1024 sc1
    s_waitcnt lgkmcnt(14)
    v_mfma_f32_16x16x32_bf16 v[36:39], v[108:111], a[136:139], v[36:39]
    ds_read_b64_tr_b16 v[92:93], v239 offset:21536
    s_mov_b32 s69, 22528
    v_mfma_f32_16x16x32_bf16 v[64:67], v[108:111], a[140:143], v[64:67]
    ds_read_b64_tr_b16 v[94:95], v239 offset:25120
    buffer_load_dwordx4 a[204:207], v241, s[28:31], s69 offen offset:1024 sc1
    s_waitcnt lgkmcnt(14)
    v_mfma_f32_16x16x32_bf16 v[40:43], v[112:115], a[136:139], v[40:43]
    ds_read_b64_tr_b16 v[96:97], v239 offset:21568
    s_add_u32 m0, s62, 159744
    v_mfma_f32_16x16x32_bf16 v[68:71], v[112:115], a[140:143], v[68:71]
    ds_read_b64_tr_b16 v[98:99], v239 offset:25152
    buffer_load_dwordx4 v255, s[20:23], s68 offen lds
    s_waitcnt lgkmcnt(14)
    v_mfma_f32_16x16x32_bf16 v[44:47], v[116:119], a[136:139], v[44:47]
    ds_read_b64_tr_b16 v[100:101], v239 offset:21600
    s_add_u32 s68, s65, 1175552
    v_mfma_f32_16x16x32_bf16 v[72:75], v[116:119], a[140:143], v[72:75]
    ds_read_b64_tr_b16 v[102:103], v239 offset:25184
    s_add_u32 m0, s62, 102400
    s_waitcnt vmcnt(17) lgkmcnt(14)
    v_mfma_f32_16x16x32_bf16 v[32:35], v[120:123], a[144:147], v[32:35]
    ds_read_b64_tr_b16 v[104:105], v239 offset:28672
    s_mov_b32 s69, 8192
    s_waitcnt vmcnt(16)
    v_mfma_f32_16x16x32_bf16 v[60:63], v[120:123], a[148:151], v[60:63]
    ds_read_b64_tr_b16 v[106:107], v239 offset:32256
    buffer_load_dwordx4 a[208:211], v241, s[28:31], s69 offen offset:2048 sc1
    s_waitcnt lgkmcnt(14)
    v_mfma_f32_16x16x32_bf16 v[36:39], v[124:127], a[144:147], v[36:39]
    ds_read_b64_tr_b16 v[108:109], v239 offset:28704
    s_mov_b32 s69, 22528
    v_mfma_f32_16x16x32_bf16 v[64:67], v[124:127], a[148:151], v[64:67]
    ds_read_b64_tr_b16 v[110:111], v239 offset:32288
    buffer_load_dwordx4 a[212:215], v241, s[28:31], s69 offen offset:2048 sc1
    s_waitcnt lgkmcnt(14)
    v_mfma_f32_16x16x32_bf16 v[40:43], v[128:131], a[144:147], v[40:43]
    ds_read_b64_tr_b16 v[112:113], v239 offset:28736
    buffer_load_dwordx4 v255, s[20:23], s68 offen lds
    v_mfma_f32_16x16x32_bf16 v[68:71], v[128:131], a[148:151], v[68:71]
    ds_read_b64_tr_b16 v[114:115], v239 offset:32320
    s_add_u32 s68, s65, 1204224
    s_waitcnt lgkmcnt(14)
    v_mfma_f32_16x16x32_bf16 v[44:47], v[132:135], a[144:147], v[44:47]
    ds_read_b64_tr_b16 v[116:117], v239 offset:28768
    s_add_u32 m0, s62, 106496
    v_mfma_f32_16x16x32_bf16 v[72:75], v[132:135], a[148:151], v[72:75]
    ds_read_b64_tr_b16 v[118:119], v239 offset:32352
    buffer_load_dwordx4 v255, s[20:23], s68 offen lds
    s_waitcnt vmcnt(19) lgkmcnt(14)
    v_mfma_f32_16x16x32_bf16 v[32:35], v[88:91], a[152:155], v[32:35]
    ds_read_b64_tr_b16 v[120:121], v239 offset:35840
    s_mov_b32 s69, 8192
    s_waitcnt vmcnt(18)
    v_mfma_f32_16x16x32_bf16 v[60:63], v[88:91], a[156:159], v[60:63]
    ds_read_b64_tr_b16 v[122:123], v239 offset:39424
    buffer_load_dwordx4 a[216:219], v241, s[28:31], s69 offen offset:3072 sc1
    s_waitcnt lgkmcnt(14)
    v_mfma_f32_16x16x32_bf16 v[36:39], v[92:95], a[152:155], v[36:39]
    ds_read_b64_tr_b16 v[124:125], v239 offset:35872
    s_mov_b32 s69, 22528
    v_mfma_f32_16x16x32_bf16 v[64:67], v[92:95], a[156:159], v[64:67]
    ds_read_b64_tr_b16 v[126:127], v239 offset:39456
    buffer_load_dwordx4 a[220:223], v241, s[28:31], s69 offen offset:3072 sc1
    s_waitcnt lgkmcnt(14)
    v_mfma_f32_16x16x32_bf16 v[40:43], v[96:99], a[152:155], v[40:43]
    ds_read_b64_tr_b16 v[128:129], v239 offset:35904
    s_add_u32 s68, s65, 1232896
    v_mfma_f32_16x16x32_bf16 v[68:71], v[96:99], a[156:159], v[68:71]
    ds_read_b64_tr_b16 v[130:131], v239 offset:39488
    s_add_u32 m0, s62, 110592
    s_waitcnt lgkmcnt(14)
    v_mfma_f32_16x16x32_bf16 v[44:47], v[100:103], a[152:155], v[44:47]
    ds_read_b64_tr_b16 v[132:133], v239 offset:35936
    buffer_load_dwordx4 v255, s[20:23], s68 offen lds
    v_mfma_f32_16x16x32_bf16 v[72:75], v[100:103], a[156:159], v[72:75]
    ds_read_b64_tr_b16 v[134:135], v239 offset:39520
    s_add_u32 s68, s65, 1261568
    s_waitcnt vmcnt(20) lgkmcnt(14)
    v_mfma_f32_16x16x32_bf16 v[32:35], v[104:107], a[160:163], v[32:35]
    ds_read_b64_tr_b16 v[88:89], v239 offset:43008
    s_mov_b32 s69, 12288
    s_waitcnt vmcnt(19)
    v_mfma_f32_16x16x32_bf16 v[60:63], v[104:107], a[164:167], v[60:63]
    ds_read_b64_tr_b16 v[90:91], v239 offset:46592
    buffer_load_dwordx4 a[224:227], v241, s[28:31], s69 offen offset:0 sc1
    s_waitcnt lgkmcnt(14)
    v_mfma_f32_16x16x32_bf16 v[36:39], v[108:111], a[160:163], v[36:39]
    ds_read_b64_tr_b16 v[92:93], v239 offset:43040
    s_mov_b32 s69, 26624
    v_mfma_f32_16x16x32_bf16 v[64:67], v[108:111], a[164:167], v[64:67]
    ds_read_b64_tr_b16 v[94:95], v239 offset:46624
    buffer_load_dwordx4 a[228:231], v241, s[28:31], s69 offen offset:0 sc1
    s_waitcnt lgkmcnt(14)
    v_mfma_f32_16x16x32_bf16 v[40:43], v[112:115], a[160:163], v[40:43]
    ds_read_b64_tr_b16 v[96:97], v239 offset:43072
    s_add_u32 m0, s62, 114688
    v_mfma_f32_16x16x32_bf16 v[68:71], v[112:115], a[164:167], v[68:71]
    ds_read_b64_tr_b16 v[98:99], v239 offset:46656
    buffer_load_dwordx4 v255, s[20:23], s68 offen lds
    s_waitcnt lgkmcnt(14)
    v_mfma_f32_16x16x32_bf16 v[44:47], v[116:119], a[160:163], v[44:47]
    ds_read_b64_tr_b16 v[100:101], v239 offset:43104
    s_add_u32 s68, s65, 1290240
    v_mfma_f32_16x16x32_bf16 v[72:75], v[116:119], a[164:167], v[72:75]
    ds_read_b64_tr_b16 v[102:103], v239 offset:46688
    s_add_u32 m0, s62, 118784
    s_waitcnt vmcnt(21) lgkmcnt(14)
    v_mfma_f32_16x16x32_bf16 v[32:35], v[120:123], a[168:171], v[32:35]
    ds_read_b64_tr_b16 v[104:105], v240 offset:0
    s_mov_b32 s69, 12288
    s_waitcnt vmcnt(20)
    v_mfma_f32_16x16x32_bf16 v[60:63], v[120:123], a[172:175], v[60:63]
    ds_read_b64_tr_b16 v[106:107], v240 offset:3584
    buffer_load_dwordx4 a[232:235], v241, s[28:31], s69 offen offset:1024 sc1
    s_waitcnt lgkmcnt(14)
    v_mfma_f32_16x16x32_bf16 v[36:39], v[124:127], a[168:171], v[36:39]
    ds_read_b64_tr_b16 v[108:109], v240 offset:32
    s_mov_b32 s69, 26624
    v_mfma_f32_16x16x32_bf16 v[64:67], v[124:127], a[172:175], v[64:67]
    ds_read_b64_tr_b16 v[110:111], v240 offset:3616
    buffer_load_dwordx4 a[236:239], v241, s[28:31], s69 offen offset:1024 sc1
    s_waitcnt lgkmcnt(14)
    v_mfma_f32_16x16x32_bf16 v[40:43], v[128:131], a[168:171], v[40:43]
    ds_read_b64_tr_b16 v[112:113], v240 offset:64
    buffer_load_dwordx4 v255, s[20:23], s68 offen lds
    v_mfma_f32_16x16x32_bf16 v[68:71], v[128:131], a[172:175], v[68:71]
    ds_read_b64_tr_b16 v[114:115], v240 offset:3648
    s_add_u32 s68, s65, 1318912
    s_waitcnt lgkmcnt(14)
    v_mfma_f32_16x16x32_bf16 v[44:47], v[132:135], a[168:171], v[44:47]
    ds_read_b64_tr_b16 v[116:117], v240 offset:96
    s_add_u32 m0, s62, 122880
    v_mfma_f32_16x16x32_bf16 v[72:75], v[132:135], a[172:175], v[72:75]
    ds_read_b64_tr_b16 v[118:119], v240 offset:3680
    buffer_load_dwordx4 v255, s[20:23], s68 offen lds
    s_waitcnt vmcnt(23) lgkmcnt(14)
    v_mfma_f32_16x16x32_bf16 v[32:35], v[88:91], a[176:179], v[32:35]
    ds_read_b64_tr_b16 v[120:121], v240 offset:7168
    s_waitcnt vmcnt(22)
    v_mfma_f32_16x16x32_bf16 v[60:63], v[88:91], a[180:183], v[60:63]
    ds_read_b64_tr_b16 v[122:123], v240 offset:10752
    s_add_u32 s68, s65, 1347584
    s_waitcnt lgkmcnt(14)
    v_mfma_f32_16x16x32_bf16 v[36:39], v[92:95], a[176:179], v[36:39]
    ds_read_b64_tr_b16 v[124:125], v240 offset:7200
    v_mfma_f32_16x16x32_bf16 v[64:67], v[92:95], a[180:183], v[64:67]
    ds_read_b64_tr_b16 v[126:127], v240 offset:10784
    s_add_u32 m0, s62, 126976
    s_waitcnt lgkmcnt(14)
    v_mfma_f32_16x16x32_bf16 v[40:43], v[96:99], a[176:179], v[40:43]
    ds_read_b64_tr_b16 v[128:129], v240 offset:7232
    v_mfma_f32_16x16x32_bf16 v[68:71], v[96:99], a[180:183], v[68:71]
    ds_read_b64_tr_b16 v[130:131], v240 offset:10816
    buffer_load_dwordx4 v255, s[20:23], s68 offen lds
    s_waitcnt lgkmcnt(14)
    v_mfma_f32_16x16x32_bf16 v[44:47], v[100:103], a[176:179], v[44:47]
    ds_read_b64_tr_b16 v[132:133], v240 offset:7264
    v_mfma_f32_16x16x32_bf16 v[72:75], v[100:103], a[180:183], v[72:75]
    ds_read_b64_tr_b16 v[134:135], v240 offset:10848
    s_add_u32 s68, s65, 1376256
    s_waitcnt vmcnt(22) lgkmcnt(14)
    v_mfma_f32_16x16x32_bf16 v[32:35], v[104:107], a[184:187], v[32:35]
    ds_read_b64_tr_b16 v[88:89], v240 offset:14336
    v_cndmask_b32 v26, v26, 0, s[98:99]
    s_waitcnt vmcnt(21)
    v_mfma_f32_16x16x32_bf16 v[60:63], v[104:107], a[188:191], v[60:63]
    ds_read_b64_tr_b16 v[90:91], v240 offset:17920
    v_cndmask_b32 v27, v27, 0, s[98:99]
    s_waitcnt lgkmcnt(14)
    v_mfma_f32_16x16x32_bf16 v[36:39], v[108:111], a[184:187], v[36:39]
    ds_read_b64_tr_b16 v[92:93], v240 offset:14368
    v_pk_add_f32 v[24:25], v[24:25], v[26:27]
    v_mov_b32 v19, v24
    v_mfma_f32_16x16x32_bf16 v[64:67], v[108:111], a[188:191], v[64:67]
    ds_read_b64_tr_b16 v[94:95], v240 offset:17952
    v_mov_b32 v20, v25
    s_waitcnt lgkmcnt(14)
    v_mfma_f32_16x16x32_bf16 v[40:43], v[112:115], a[184:187], v[40:43]
    ds_read_b64_tr_b16 v[96:97], v240 offset:14400
    v_permlane32_swap_b32 v24, v19
    v_mfma_f32_16x16x32_bf16 v[68:71], v[112:115], a[188:191], v[68:71]
    ds_read_b64_tr_b16 v[98:99], v240 offset:17984
    v_permlane32_swap_b32 v25, v20
    s_add_u32 m0, s62, 131072
    s_waitcnt lgkmcnt(14)
    v_mfma_f32_16x16x32_bf16 v[44:47], v[116:119], a[184:187], v[44:47]
    ds_read_b64_tr_b16 v[100:101], v240 offset:14432
    buffer_load_dwordx4 v255, s[20:23], s68 offen lds
    v_mfma_f32_16x16x32_bf16 v[72:75], v[116:119], a[188:191], v[72:75]
    ds_read_b64_tr_b16 v[102:103], v240 offset:18016
    s_add_u32 s68, s65, 1404928
    s_add_u32 m0, s62, 135168
    s_waitcnt vmcnt(21) lgkmcnt(14)
    v_mfma_f32_16x16x32_bf16 v[32:35], v[120:123], a[192:195], v[32:35]
    ds_read_b64_tr_b16 v[104:105], v240 offset:21504
    v_add_f32 v24, v24, v19
    s_waitcnt vmcnt(20)
    v_mfma_f32_16x16x32_bf16 v[60:63], v[120:123], a[196:199], v[60:63]
    ds_read_b64_tr_b16 v[106:107], v240 offset:25088
    v_add_f32 v25, v25, v20
    s_waitcnt lgkmcnt(14)
    v_mfma_f32_16x16x32_bf16 v[36:39], v[124:127], a[192:195], v[36:39]
    ds_read_b64_tr_b16 v[108:109], v240 offset:21536
    v_mov_b32 v19, v24
    v_mov_b32 v20, v25
    v_mfma_f32_16x16x32_bf16 v[64:67], v[124:127], a[196:199], v[64:67]
    ds_read_b64_tr_b16 v[110:111], v240 offset:25120
    v_permlane16_swap_b32 v24, v19
    s_waitcnt lgkmcnt(14)
    v_mfma_f32_16x16x32_bf16 v[40:43], v[128:131], a[192:195], v[40:43]
    ds_read_b64_tr_b16 v[112:113], v240 offset:21568
    v_permlane16_swap_b32 v25, v20
    v_mfma_f32_16x16x32_bf16 v[68:71], v[128:131], a[196:199], v[68:71]
    ds_read_b64_tr_b16 v[114:115], v240 offset:25152
    v_add_f32 v24, v24, v19
    buffer_load_dwordx4 v255, s[20:23], s68 offen lds
    s_waitcnt lgkmcnt(14)
    v_mfma_f32_16x16x32_bf16 v[44:47], v[132:135], a[192:195], v[44:47]
    ds_read_b64_tr_b16 v[116:117], v240 offset:21600
    s_add_u32 s68, s65, 1433600
    v_mfma_f32_16x16x32_bf16 v[72:75], v[132:135], a[196:199], v[72:75]
    ds_read_b64_tr_b16 v[118:119], v240 offset:25184
    s_add_u32 m0, s62, 139264
    s_nop 0
    buffer_load_dwordx4 v255, s[20:23], s68 offen lds
    s_waitcnt vmcnt(20) lgkmcnt(14)
    v_mfma_f32_16x16x32_bf16 v[32:35], v[88:91], a[200:203], v[32:35]
    ds_read_b64_tr_b16 v[120:121], v240 offset:28672
    v_add_f32 v25, v25, v20
    s_waitcnt vmcnt(19)
    v_mfma_f32_16x16x32_bf16 v[60:63], v[88:91], a[204:207], v[60:63]
    ds_read_b64_tr_b16 v[122:123], v240 offset:32256
    v_mul_f32 v24, -0.002232142857142857, v24
    s_waitcnt lgkmcnt(14)
    v_mfma_f32_16x16x32_bf16 v[36:39], v[92:95], a[200:203], v[36:39]
    ds_read_b64_tr_b16 v[124:125], v240 offset:28704
    v_mul_f32 v25, 0.002232142857142857, v25
    v_fma_f32 v25, -v24, v24, v25
    v_mfma_f32_16x16x32_bf16 v[64:67], v[92:95], a[204:207], v[64:67]
    ds_read_b64_tr_b16 v[126:127], v240 offset:32288
    v_max_f32 v25, 0, v25
    s_waitcnt lgkmcnt(14)
    v_mfma_f32_16x16x32_bf16 v[40:43], v[96:99], a[200:203], v[40:43]
    ds_read_b64_tr_b16 v[128:129], v240 offset:28736
    v_add_f32 v25, 0x3727c5ac, v25
    v_mfma_f32_16x16x32_bf16 v[68:71], v[96:99], a[204:207], v[68:71]
    ds_read_b64_tr_b16 v[130:131], v240 offset:32320
    v_rsq_f32 v25, v25
    s_add_u32 s68, s65, 1462272
    s_waitcnt lgkmcnt(14)
    v_mfma_f32_16x16x32_bf16 v[44:47], v[100:103], a[200:203], v[44:47]
    ds_read_b64_tr_b16 v[132:133], v240 offset:28768
    s_add_u32 m0, s62, 143360
    v_mfma_f32_16x16x32_bf16 v[72:75], v[100:103], a[204:207], v[72:75]
    ds_read_b64_tr_b16 v[134:135], v240 offset:32352
    buffer_load_dwordx4 v255, s[20:23], s68 offen lds
    s_add_u32 s68, s65, 1490944
    s_waitcnt vmcnt(18) lgkmcnt(14)
    v_mfma_f32_16x16x32_bf16 v[32:35], v[104:107], a[208:211], v[32:35]
    ds_read_b64_tr_b16 v[88:89], v240 offset:35840
    v_cndmask_b32 v30, v30, 0, s[98:99]
    s_waitcnt vmcnt(17)
    v_mfma_f32_16x16x32_bf16 v[60:63], v[104:107], a[212:215], v[60:63]
    ds_read_b64_tr_b16 v[90:91], v240 offset:39424
    v_cndmask_b32 v31, v31, 0, s[98:99]
    s_waitcnt lgkmcnt(14)
    v_mfma_f32_16x16x32_bf16 v[36:39], v[108:111], a[208:211], v[36:39]
    ds_read_b64_tr_b16 v[92:93], v240 offset:35872
    v_pk_add_f32 v[28:29], v[28:29], v[30:31]
    v_mov_b32 v19, v28
    v_mfma_f32_16x16x32_bf16 v[64:67], v[108:111], a[212:215], v[64:67]
    ds_read_b64_tr_b16 v[94:95], v240 offset:39456
    v_mov_b32 v20, v29
    s_waitcnt lgkmcnt(14)
    v_mfma_f32_16x16x32_bf16 v[40:43], v[112:115], a[208:211], v[40:43]
    ds_read_b64_tr_b16 v[96:97], v240 offset:35904
    v_permlane32_swap_b32 v28, v19
    v_mfma_f32_16x16x32_bf16 v[68:71], v[112:115], a[212:215], v[68:71]
    ds_read_b64_tr_b16 v[98:99], v240 offset:39488
    v_permlane32_swap_b32 v29, v20
    s_add_u32 m0, s62, 147456
    s_waitcnt lgkmcnt(14)
    v_mfma_f32_16x16x32_bf16 v[44:47], v[116:119], a[208:211], v[44:47]
    ds_read_b64_tr_b16 v[100:101], v240 offset:35936
    buffer_load_dwordx4 v255, s[20:23], s68 offen lds
    v_mfma_f32_16x16x32_bf16 v[72:75], v[116:119], a[212:215], v[72:75]
    ds_read_b64_tr_b16 v[102:103], v240 offset:39520
    s_add_u32 s68, s65, 1519616
    s_add_u32 m0, s62, 151552
    s_waitcnt vmcnt(15) lgkmcnt(14)
    v_mfma_f32_16x16x32_bf16 v[32:35], v[120:123], a[216:219], v[32:35]
    ds_read_b64_tr_b16 v[104:105], v240 offset:43008
    v_add_f32 v28, v28, v19
    s_waitcnt vmcnt(14)
    v_mfma_f32_16x16x32_bf16 v[60:63], v[120:123], a[220:223], v[60:63]
    ds_read_b64_tr_b16 v[106:107], v240 offset:46592
    v_add_f32 v29, v29, v20
    s_waitcnt lgkmcnt(14)
    v_mfma_f32_16x16x32_bf16 v[36:39], v[124:127], a[216:219], v[36:39]
    ds_read_b64_tr_b16 v[108:109], v240 offset:43040
    v_mov_b32 v19, v28
    v_mfma_f32_16x16x32_bf16 v[64:67], v[124:127], a[220:223], v[64:67]
    ds_read_b64_tr_b16 v[110:111], v240 offset:46624
    v_mov_b32 v20, v29
    s_waitcnt lgkmcnt(14)
    v_mfma_f32_16x16x32_bf16 v[40:43], v[128:131], a[216:219], v[40:43]
    ds_read_b64_tr_b16 v[112:113], v240 offset:43072
    v_permlane16_swap_b32 v28, v19
    v_mfma_f32_16x16x32_bf16 v[68:71], v[128:131], a[220:223], v[68:71]
    ds_read_b64_tr_b16 v[114:115], v240 offset:46656
    v_permlane16_swap_b32 v29, v20
    s_waitcnt lgkmcnt(14)
    v_mfma_f32_16x16x32_bf16 v[44:47], v[132:135], a[216:219], v[44:47]
    ds_read_b64_tr_b16 v[116:117], v240 offset:43104
    v_add_f32 v28, v28, v19
    v_mfma_f32_16x16x32_bf16 v[72:75], v[132:135], a[220:223], v[72:75]
    ds_read_b64_tr_b16 v[118:119], v240 offset:46688
    buffer_load_dwordx4 v255, s[20:23], s68 offen lds
    s_waitcnt vmcnt(13) lgkmcnt(14)
    v_mfma_f32_16x16x32_bf16 v[32:35], v[88:91], a[224:227], v[32:35]
    s_waitcnt vmcnt(12)
    v_mfma_f32_16x16x32_bf16 v[60:63], v[88:91], a[228:231], v[60:63]
    ds_read_b64_tr_b16 v[136:137], v239 offset:128
    v_add_f32 v29, v29, v20
    s_waitcnt lgkmcnt(13)
    v_mfma_f32_16x16x32_bf16 v[36:39], v[92:95], a[224:227], v[36:39]
    ds_read_b64_tr_b16 v[138:139], v239 offset:3712
    v_mul_f32 v28, -0.002232142857142857, v28
    v_mfma_f32_16x16x32_bf16 v[64:67], v[92:95], a[228:231], v[64:67]
    ds_read_b64_tr_b16 v[140:141], v239 offset:160
    v_mul_f32 v29, 0.002232142857142857, v29
    s_waitcnt lgkmcnt(13)
    v_mfma_f32_16x16x32_bf16 v[40:43], v[96:99], a[224:227], v[40:43]
    v_fma_f32 v29, -v28, v28, v29
    v_mfma_f32_16x16x32_bf16 v[68:71], v[96:99], a[228:231], v[68:71]
    ds_read_b64_tr_b16 v[142:143], v239 offset:3744
    v_max_f32 v29, 0, v29
    s_waitcnt lgkmcnt(12)
    v_mfma_f32_16x16x32_bf16 v[44:47], v[100:103], a[224:227], v[44:47]
    ds_read_b64_tr_b16 v[144:145], v239 offset:192
    v_add_f32 v29, 0x3727c5ac, v29
    v_mfma_f32_16x16x32_bf16 v[72:75], v[100:103], a[228:231], v[72:75]
    ds_read_b64_tr_b16 v[146:147], v239 offset:3776
    v_rsq_f32 v29, v29
    s_waitcnt vmcnt(10) lgkmcnt(12)
    v_mfma_f32_16x16x32_bf16 v[32:35], v[104:107], a[232:235], v[32:35]
    s_waitcnt vmcnt(9)
    v_mfma_f32_16x16x32_bf16 v[60:63], v[104:107], a[236:239], v[60:63]
    ds_read_b64_tr_b16 v[148:149], v239 offset:7296
    s_waitcnt lgkmcnt(11)
    v_mfma_f32_16x16x32_bf16 v[36:39], v[108:111], a[232:235], v[36:39]
    ds_read_b64_tr_b16 v[150:151], v239 offset:10880
    v_mfma_f32_16x16x32_bf16 v[64:67], v[108:111], a[236:239], v[64:67]
    ds_read_b64_tr_b16 v[152:153], v239 offset:7328
    s_waitcnt lgkmcnt(11)
    v_mfma_f32_16x16x32_bf16 v[40:43], v[112:115], a[232:235], v[40:43]
    v_mfma_f32_16x16x32_bf16 v[68:71], v[112:115], a[236:239], v[68:71]
    ds_read_b64_tr_b16 v[154:155], v239 offset:10912
    s_waitcnt lgkmcnt(10)
    v_mfma_f32_16x16x32_bf16 v[44:47], v[116:119], a[232:235], v[44:47]
    ds_read_b64_tr_b16 v[156:157], v239 offset:7360
    v_mfma_f32_16x16x32_bf16 v[72:75], v[116:119], a[236:239], v[72:75]
    ds_read_b64_tr_b16 v[158:159], v239 offset:10944
    s_waitcnt lgkmcnt(10)
    v_mfma_f32_16x16x32_bf16 v[48:51], v[136:139], a[128:131], 0
    ds_read_b64_tr_b16 v[160:161], v239 offset:14464
    v_mfma_f32_16x16x32_bf16 v[76:79], v[136:139], a[132:135], 0
    ds_read_b64_tr_b16 v[162:163], v239 offset:18048
    s_waitcnt lgkmcnt(10)
    v_mfma_f32_16x16x32_bf16 v[52:55], v[140:143], a[128:131], 0
    ds_read_b64_tr_b16 v[164:165], v239 offset:14496
    v_mfma_f32_16x16x32_bf16 v[80:83], v[140:143], a[132:135], 0
    ds_read_b64_tr_b16 v[166:167], v239 offset:18080
    s_waitcnt lgkmcnt(10)
    v_mfma_f32_16x16x32_bf16 v[56:59], v[144:147], a[128:131], 0
    ds_read_b64_tr_b16 v[168:169], v239 offset:14528
    v_mfma_f32_16x16x32_bf16 v[84:87], v[144:147], a[132:135], 0
    ds_read_b64_tr_b16 v[170:171], v239 offset:18112
    s_waitcnt lgkmcnt(10)
    v_mfma_f32_16x16x32_bf16 v[48:51], v[148:151], a[136:139], v[48:51]
    ds_read_b64_tr_b16 v[136:137], v239 offset:21632
    v_fmac_f32 v32, v172, v24
    v_mfma_f32_16x16x32_bf16 v[76:79], v[148:151], a[140:143], v[76:79]
    ds_read_b64_tr_b16 v[138:139], v239 offset:25216
    v_fmac_f32 v33, v173, v24
    s_waitcnt lgkmcnt(10)
    v_mfma_f32_16x16x32_bf16 v[52:55], v[152:155], a[136:139], v[52:55]
    ds_read_b64_tr_b16 v[140:141], v239 offset:21664
    v_fmac_f32 v34, v174, v24
    v_mfma_f32_16x16x32_bf16 v[80:83], v[152:155], a[140:143], v[80:83]
    ds_read_b64_tr_b16 v[142:143], v239 offset:25248
    v_fmac_f32 v35, v175, v24
    s_waitcnt lgkmcnt(10)
    v_mfma_f32_16x16x32_bf16 v[56:59], v[156:159], a[136:139], v[56:59]
    ds_read_b64_tr_b16 v[144:145], v239 offset:21696
    v_fmac_f32 v60, v172, v28
    v_mfma_f32_16x16x32_bf16 v[84:87], v[156:159], a[140:143], v[84:87]
    ds_read_b64_tr_b16 v[146:147], v239 offset:25280
    v_fmac_f32 v61, v173, v28
    s_waitcnt lgkmcnt(10)
    v_mfma_f32_16x16x32_bf16 v[48:51], v[160:163], a[144:147], v[48:51]
    ds_read_b64_tr_b16 v[148:149], v239 offset:28800
    v_fmac_f32 v62, v174, v28
    v_mfma_f32_16x16x32_bf16 v[76:79], v[160:163], a[148:151], v[76:79]
    ds_read_b64_tr_b16 v[150:151], v239 offset:32384
    v_fmac_f32 v63, v175, v28
    s_waitcnt lgkmcnt(10)
    v_mfma_f32_16x16x32_bf16 v[52:55], v[164:167], a[144:147], v[52:55]
    ds_read_b64_tr_b16 v[152:153], v239 offset:28832
    v_cvt_pk_bf16_f32 v200, v32, v33
    v_mfma_f32_16x16x32_bf16 v[80:83], v[164:167], a[148:151], v[80:83]
    ds_read_b64_tr_b16 v[154:155], v239 offset:32416
    v_cvt_pk_bf16_f32 v201, v34, v35
    s_waitcnt lgkmcnt(10)
    v_mfma_f32_16x16x32_bf16 v[56:59], v[168:171], a[144:147], v[56:59]
    ds_read_b64_tr_b16 v[156:157], v239 offset:28864
    v_cvt_pk_bf16_f32 v202, v60, v61
    v_mfma_f32_16x16x32_bf16 v[84:87], v[168:171], a[148:151], v[84:87]
    ds_read_b64_tr_b16 v[158:159], v239 offset:32448
    v_cvt_pk_bf16_f32 v203, v62, v63
    s_waitcnt lgkmcnt(10)
    v_mfma_f32_16x16x32_bf16 v[48:51], v[136:139], a[152:155], v[48:51]
    ds_read_b64_tr_b16 v[160:161], v239 offset:35968
    v_pk_max_i16 v200, v200, 0
    v_mfma_f32_16x16x32_bf16 v[76:79], v[136:139], a[156:159], v[76:79]
    ds_read_b64_tr_b16 v[162:163], v239 offset:39552
    v_pk_max_i16 v201, v201, 0
    s_waitcnt lgkmcnt(10)
    v_mfma_f32_16x16x32_bf16 v[52:55], v[140:143], a[152:155], v[52:55]
    ds_read_b64_tr_b16 v[164:165], v239 offset:36000
    v_pk_max_i16 v202, v202, 0
    v_mfma_f32_16x16x32_bf16 v[80:83], v[140:143], a[156:159], v[80:83]
    ds_read_b64_tr_b16 v[166:167], v239 offset:39584
    v_pk_max_i16 v203, v203, 0
    s_waitcnt lgkmcnt(10)
    v_mfma_f32_16x16x32_bf16 v[56:59], v[144:147], a[152:155], v[56:59]
    ds_read_b64_tr_b16 v[168:169], v239 offset:36032
    v_permlane16_swap_b32 v200, v202
    v_mfma_f32_16x16x32_bf16 v[84:87], v[144:147], a[156:159], v[84:87]
    ds_read_b64_tr_b16 v[170:171], v239 offset:39616
    v_permlane16_swap_b32 v201, v203
    s_waitcnt lgkmcnt(10)
    v_mfma_f32_16x16x32_bf16 v[48:51], v[148:151], a[160:163], v[48:51]
    ds_read_b64_tr_b16 v[136:137], v239 offset:43136
    buffer_store_dwordx4 v[200:203], v248, s[28:31], 0 offen offset:0 sc1
    v_mfma_f32_16x16x32_bf16 v[76:79], v[148:151], a[164:167], v[76:79]
    ds_read_b64_tr_b16 v[138:139], v239 offset:46720
    v_fmac_f32 v36, v176, v24
    s_waitcnt lgkmcnt(10)
    v_mfma_f32_16x16x32_bf16 v[52:55], v[152:155], a[160:163], v[52:55]
    ds_read_b64_tr_b16 v[140:141], v239 offset:43168
    v_fmac_f32 v37, v177, v24
    v_mfma_f32_16x16x32_bf16 v[80:83], v[152:155], a[164:167], v[80:83]
    ds_read_b64_tr_b16 v[142:143], v239 offset:46752
    v_fmac_f32 v38, v178, v24
    s_waitcnt lgkmcnt(10)
    v_mfma_f32_16x16x32_bf16 v[56:59], v[156:159], a[160:163], v[56:59]
    ds_read_b64_tr_b16 v[144:145], v239 offset:43200
    v_fmac_f32 v39, v179, v24
    v_mfma_f32_16x16x32_bf16 v[84:87], v[156:159], a[164:167], v[84:87]
    ds_read_b64_tr_b16 v[146:147], v239 offset:46784
    v_fmac_f32 v64, v176, v28
    s_waitcnt lgkmcnt(10)
    v_mfma_f32_16x16x32_bf16 v[48:51], v[160:163], a[168:171], v[48:51]
    ds_read_b64_tr_b16 v[148:149], v240 offset:128
    v_fmac_f32 v65, v177, v28
    v_mfma_f32_16x16x32_bf16 v[76:79], v[160:163], a[172:175], v[76:79]
    ds_read_b64_tr_b16 v[150:151], v240 offset:3712
    v_fmac_f32 v66, v178, v28
    s_waitcnt lgkmcnt(10)
    v_mfma_f32_16x16x32_bf16 v[52:55], v[164:167], a[168:171], v[52:55]
    ds_read_b64_tr_b16 v[152:153], v240 offset:160
    v_fmac_f32 v67, v179, v28
    v_mfma_f32_16x16x32_bf16 v[80:83], v[164:167], a[172:175], v[80:83]
    ds_read_b64_tr_b16 v[154:155], v240 offset:3744
    v_cvt_pk_bf16_f32 v204, v36, v37
    s_waitcnt lgkmcnt(10)
    v_mfma_f32_16x16x32_bf16 v[56:59], v[168:171], a[168:171], v[56:59]
    ds_read_b64_tr_b16 v[156:157], v240 offset:192
    v_cvt_pk_bf16_f32 v205, v38, v39
    v_mfma_f32_16x16x32_bf16 v[84:87], v[168:171], a[172:175], v[84:87]
    ds_read_b64_tr_b16 v[158:159], v240 offset:3776
    v_cvt_pk_bf16_f32 v206, v64, v65
    s_waitcnt lgkmcnt(10)
    v_mfma_f32_16x16x32_bf16 v[48:51], v[136:139], a[176:179], v[48:51]
    s_barrier
    v_mfma_f32_16x16x32_bf16 v[76:79], v[136:139], a[180:183], v[76:79]
    ds_read_b64_tr_b16 v[160:161], v240 offset:7296
    s_add_u32 s68, s65, 229376
    s_waitcnt lgkmcnt(9)
    v_mfma_f32_16x16x32_bf16 v[52:55], v[140:143], a[176:179], v[52:55]
    ds_read_b64_tr_b16 v[162:163], v240 offset:10880
    s_add_u32 m0, s62, 0
    s_nop 0
    buffer_load_dwordx4 v255, s[20:23], s68 offen lds
    v_mfma_f32_16x16x32_bf16 v[80:83], v[140:143], a[180:183], v[80:83]
    ds_read_b64_tr_b16 v[164:165], v240 offset:7328
    v_cvt_pk_bf16_f32 v207, v66, v67
    v_pk_max_i16 v204, v204, 0
    s_waitcnt lgkmcnt(9)
    v_mfma_f32_16x16x32_bf16 v[56:59], v[144:147], a[176:179], v[56:59]
    ds_read_b64_tr_b16 v[166:167], v240 offset:10912
    v_pk_max_i16 v205, v205, 0
    v_pk_max_i16 v206, v206, 0
    v_mfma_f32_16x16x32_bf16 v[84:87], v[144:147], a[180:183], v[84:87]
    ds_read_b64_tr_b16 v[168:169], v240 offset:7360
    ds_read_b64_tr_b16 v[170:171], v240 offset:10944
    v_pk_max_i16 v207, v207, 0
    v_permlane16_swap_b32 v204, v206
    s_waitcnt lgkmcnt(10)
    v_mfma_f32_16x16x32_bf16 v[48:51], v[148:151], a[184:187], v[48:51]
    ds_read_b64_tr_b16 v[136:137], v240 offset:14464
    s_add_u32 s68, s65, 258048
    s_add_u32 m0, s62, 4096
    v_mfma_f32_16x16x32_bf16 v[76:79], v[148:151], a[188:191], v[76:79]
    ds_read_b64_tr_b16 v[138:139], v240 offset:18048
    buffer_load_dwordx4 v255, s[20:23], s68 offen lds
    s_add_u32 s68, s65, 286720
    s_waitcnt lgkmcnt(10)
    v_mfma_f32_16x16x32_bf16 v[52:55], v[152:155], a[184:187], v[52:55]
    ds_read_b64_tr_b16 v[140:141], v240 offset:14496
    s_add_u32 m0, s62, 8192
    s_nop 0
    buffer_load_dwordx4 v255, s[20:23], s68 offen lds
    v_mfma_f32_16x16x32_bf16 v[80:83], v[152:155], a[188:191], v[80:83]
    ds_read_b64_tr_b16 v[142:143], v240 offset:18080
    v_permlane16_swap_b32 v205, v207
    buffer_store_dwordx4 v[204:207], v248, s[28:31], 0 offen offset:1024 sc1
    s_waitcnt lgkmcnt(10)
    v_mfma_f32_16x16x32_bf16 v[56:59], v[156:159], a[184:187], v[56:59]
    ds_read_b64_tr_b16 v[144:145], v240 offset:14528
    v_fmac_f32 v40, v180, v24
    v_fmac_f32 v41, v181, v24
    v_mfma_f32_16x16x32_bf16 v[84:87], v[156:159], a[188:191], v[84:87]
    ds_read_b64_tr_b16 v[146:147], v240 offset:18112
    v_fmac_f32 v42, v182, v24
    v_fmac_f32 v43, v183, v24
    s_waitcnt lgkmcnt(10)
    v_mfma_f32_16x16x32_bf16 v[48:51], v[160:163], a[192:195], v[48:51]
    ds_read_b64_tr_b16 v[148:149], v240 offset:21632
    s_add_u32 s68, s65, 315392
    s_add_u32 m0, s62, 12288
    v_mfma_f32_16x16x32_bf16 v[76:79], v[160:163], a[196:199], v[76:79]
    ds_read_b64_tr_b16 v[150:151], v240 offset:25216
    buffer_load_dwordx4 v255, s[20:23], s68 offen lds
    s_add_u32 s68, s65, 344064
    s_waitcnt lgkmcnt(10)
    v_mfma_f32_16x16x32_bf16 v[52:55], v[164:167], a[192:195], v[52:55]
    ds_read_b64_tr_b16 v[152:153], v240 offset:21664
    s_add_u32 m0, s62, 16384
    s_nop 0
    buffer_load_dwordx4 v255, s[20:23], s68 offen lds
    v_mfma_f32_16x16x32_bf16 v[80:83], v[164:167], a[196:199], v[80:83]
    ds_read_b64_tr_b16 v[154:155], v240 offset:25248
    v_fmac_f32 v68, v180, v28
    v_fmac_f32 v69, v181, v28
    s_waitcnt lgkmcnt(10)
    v_mfma_f32_16x16x32_bf16 v[56:59], v[168:171], a[192:195], v[56:59]
    ds_read_b64_tr_b16 v[156:157], v240 offset:21696
    v_fmac_f32 v70, v182, v28
    v_fmac_f32 v71, v183, v28
    v_mfma_f32_16x16x32_bf16 v[84:87], v[168:171], a[196:199], v[84:87]
    ds_read_b64_tr_b16 v[158:159], v240 offset:25280
    v_cvt_pk_bf16_f32 v208, v40, v41
    v_cvt_pk_bf16_f32 v209, v42, v43
    s_waitcnt lgkmcnt(10)
    v_mfma_f32_16x16x32_bf16 v[48:51], v[136:139], a[200:203], v[48:51]
    ds_read_b64_tr_b16 v[160:161], v240 offset:28800
    s_add_u32 s68, s65, 372736
    s_add_u32 m0, s62, 20480
    v_mfma_f32_16x16x32_bf16 v[76:79], v[136:139], a[204:207], v[76:79]
    ds_read_b64_tr_b16 v[162:163], v240 offset:32384
    buffer_load_dwordx4 v255, s[20:23], s68 offen lds
    s_add_u32 s68, s65, 401408
    s_waitcnt lgkmcnt(10)
    v_mfma_f32_16x16x32_bf16 v[52:55], v[140:143], a[200:203], v[52:55]
    ds_read_b64_tr_b16 v[164:165], v240 offset:28832
    s_add_u32 m0, s62, 24576
    s_nop 0
    buffer_load_dwordx4 v255, s[20:23], s68 offen lds
    v_mfma_f32_16x16x32_bf16 v[80:83], v[140:143], a[204:207], v[80:83]
    ds_read_b64_tr_b16 v[166:167], v240 offset:32416
    v_cvt_pk_bf16_f32 v210, v68, v69
    v_cvt_pk_bf16_f32 v211, v70, v71
    s_waitcnt lgkmcnt(10)
    v_mfma_f32_16x16x32_bf16 v[56:59], v[144:147], a[200:203], v[56:59]
    ds_read_b64_tr_b16 v[168:169], v240 offset:28864
    v_pk_max_i16 v208, v208, 0
    v_pk_max_i16 v209, v209, 0
    v_mfma_f32_16x16x32_bf16 v[84:87], v[144:147], a[204:207], v[84:87]
    ds_read_b64_tr_b16 v[170:171], v240 offset:32448
    v_pk_max_i16 v210, v210, 0
    v_pk_max_i16 v211, v211, 0
    s_waitcnt lgkmcnt(10)
    v_mfma_f32_16x16x32_bf16 v[48:51], v[148:151], a[208:211], v[48:51]
    s_barrier
    v_mfma_f32_16x16x32_bf16 v[76:79], v[148:151], a[212:215], v[76:79]
    ds_read_b64_tr_b16 v[136:137], v240 offset:35968
    s_add_u32 s68, s65, 430080
    s_waitcnt lgkmcnt(9)
    v_mfma_f32_16x16x32_bf16 v[52:55], v[152:155], a[208:211], v[52:55]
    ds_read_b64_tr_b16 v[138:139], v240 offset:39552
    s_add_u32 m0, s62, 28672
    s_nop 0
    buffer_load_dwordx4 v255, s[20:23], s68 offen lds
    v_mfma_f32_16x16x32_bf16 v[80:83], v[152:155], a[212:215], v[80:83]
    ds_read_b64_tr_b16 v[140:141], v240 offset:36000
    v_permlane16_swap_b32 v208, v210
    v_permlane16_swap_b32 v209, v211
    s_waitcnt lgkmcnt(9)
    v_mfma_f32_16x16x32_bf16 v[56:59], v[156:159], a[208:211], v[56:59]
    ds_read_b64_tr_b16 v[142:143], v240 offset:39584
    buffer_store_dwordx4 v[208:211], v248, s[28:31], 0 offen offset:2048 sc1
    v_fmac_f32 v44, v184, v24
    v_mfma_f32_16x16x32_bf16 v[84:87], v[156:159], a[212:215], v[84:87]
    ds_read_b64_tr_b16 v[144:145], v240 offset:36032
    ds_read_b64_tr_b16 v[146:147], v240 offset:39616
    v_fmac_f32 v45, v185, v24
    v_fmac_f32 v46, v186, v24
    s_waitcnt lgkmcnt(10)
    v_mfma_f32_16x16x32_bf16 v[48:51], v[160:163], a[216:219], v[48:51]
    ds_read_b64_tr_b16 v[148:149], v240 offset:43136
    s_add_u32 s68, s65, 458752
    s_add_u32 m0, s62, 32768
    v_mfma_f32_16x16x32_bf16 v[76:79], v[160:163], a[220:223], v[76:79]
    ds_read_b64_tr_b16 v[150:151], v240 offset:46720
    buffer_load_dwordx4 v255, s[20:23], s68 offen lds
    s_add_u32 s68, s65, 487424
    s_waitcnt lgkmcnt(10)
    v_mfma_f32_16x16x32_bf16 v[52:55], v[164:167], a[216:219], v[52:55]
    ds_read_b64_tr_b16 v[152:153], v240 offset:43168
    s_add_u32 m0, s62, 36864
    s_nop 0
    buffer_load_dwordx4 v255, s[20:23], s68 offen lds
    v_mfma_f32_16x16x32_bf16 v[80:83], v[164:167], a[220:223], v[80:83]
    ds_read_b64_tr_b16 v[154:155], v240 offset:46752
    v_fmac_f32 v47, v187, v24
    v_fmac_f32 v72, v184, v28
    s_waitcnt lgkmcnt(10)
    v_mfma_f32_16x16x32_bf16 v[56:59], v[168:171], a[216:219], v[56:59]
    ds_read_b64_tr_b16 v[156:157], v240 offset:43200
    v_fmac_f32 v73, v185, v28
    v_fmac_f32 v74, v186, v28
    v_mfma_f32_16x16x32_bf16 v[84:87], v[168:171], a[220:223], v[84:87]
    ds_read_b64_tr_b16 v[158:159], v240 offset:46784
    v_fmac_f32 v75, v187, v28
    v_cvt_pk_bf16_f32 v200, v44, v45
    s_waitcnt lgkmcnt(10)
    v_mfma_f32_16x16x32_bf16 v[48:51], v[136:139], a[224:227], v[48:51]
    s_add_u32 s68, s65, 516096
    s_add_u32 m0, s62, 40960
    v_mfma_f32_16x16x32_bf16 v[76:79], v[136:139], a[228:231], v[76:79]
    buffer_load_dwordx4 v255, s[20:23], s68 offen lds
    s_add_u32 s68, s65, 544768
    s_waitcnt lgkmcnt(8)
    v_mfma_f32_16x16x32_bf16 v[52:55], v[140:143], a[224:227], v[52:55]
    s_add_u32 m0, s62, 45056
    s_nop 0
    buffer_load_dwordx4 v255, s[20:23], s68 offen lds
    v_mfma_f32_16x16x32_bf16 v[80:83], v[140:143], a[228:231], v[80:83]
    v_cvt_pk_bf16_f32 v201, v46, v47
    v_cvt_pk_bf16_f32 v202, v72, v73
    s_waitcnt lgkmcnt(6)
    v_mfma_f32_16x16x32_bf16 v[56:59], v[144:147], a[224:227], v[56:59]
    v_cvt_pk_bf16_f32 v203, v74, v75
    v_pk_max_i16 v200, v200, 0
    v_mfma_f32_16x16x32_bf16 v[84:87], v[144:147], a[228:231], v[84:87]
    v_pk_max_i16 v201, v201, 0
    v_pk_max_i16 v202, v202, 0
    s_waitcnt lgkmcnt(4)
    v_mfma_f32_16x16x32_bf16 v[48:51], v[148:151], a[232:235], v[48:51]
    s_add_u32 s68, s65, 573440
    v_mfma_f32_16x16x32_bf16 v[76:79], v[148:151], a[236:239], v[76:79]
    s_add_u32 m0, s62, 49152
    s_nop 0
    buffer_load_dwordx4 v255, s[20:23], s68 offen lds
    s_waitcnt lgkmcnt(2)
    v_mfma_f32_16x16x32_bf16 v[52:55], v[152:155], a[232:235], v[52:55]
    s_add_u32 s68, s65, 602112
    s_add_u32 m0, s62, 53248
    v_mfma_f32_16x16x32_bf16 v[80:83], v[152:155], a[236:239], v[80:83]
    buffer_load_dwordx4 v255, s[20:23], s68 offen lds
    s_waitcnt lgkmcnt(0)
    v_mfma_f32_16x16x32_bf16 v[56:59], v[156:159], a[232:235], v[56:59]
    v_pk_max_i16 v203, v203, 0
    v_permlane16_swap_b32 v200, v202
    v_mfma_f32_16x16x32_bf16 v[84:87], v[156:159], a[236:239], v[84:87]
    v_permlane16_swap_b32 v201, v203
    buffer_store_dwordx4 v[200:203], v248, s[28:31], 0 offen offset:3072 sc1
    s_mul_i32 s69, s59, -24576
    s_add_u32 s69, s69, 53248
    v_add_u32 v12, s69, v12
    v_add_u32 v13, s69, v13
    s_waitcnt vmcnt(18)
    s_barrier
    ds_read_b64_tr_b16 a[112:113], v12 offset:0
    ds_read_b64_tr_b16 a[114:115], v12 offset:512
    ds_read_b64_tr_b16 a[116:117], v13 offset:0
    ds_read_b64_tr_b16 a[118:119], v13 offset:512
    ds_read_b64_tr_b16 a[120:121], v12 offset:2048
    ds_read_b64_tr_b16 a[122:123], v12 offset:2560
    ds_read_b64_tr_b16 a[124:125], v13 offset:2048
    ds_read_b64_tr_b16 a[126:127], v13 offset:2560
    s_waitcnt lgkmcnt(0)
    s_barrier
    s_add_u32 s68, s65, 1032192
    s_add_u32 m0, s62, 81920
    s_nop 0
    buffer_load_dwordx4 v255, s[20:23], s68 offen lds
    v_pk_fma_f32 v[48:49], v[188:189], v[24:25], v[48:49] op_sel:[0,0,0] op_sel_hi:[1,0,1]
    v_pk_fma_f32 v[50:51], v[190:191], v[24:25], v[50:51] op_sel:[0,0,0] op_sel_hi:[1,0,1]
    v_pk_fma_f32 v[76:77], v[188:189], v[28:29], v[76:77] op_sel:[0,0,0] op_sel_hi:[1,0,1]
    v_pk_fma_f32 v[78:79], v[190:191], v[28:29], v[78:79] op_sel:[0,0,0] op_sel_hi:[1,0,1]
    v_cvt_pk_bf16_f32 v204, v48, v49
    v_cvt_pk_bf16_f32 v205, v50, v51
    v_cvt_pk_bf16_f32 v206, v76, v77
    v_cvt_pk_bf16_f32 v207, v78, v79
    v_pk_max_i16 v204, v204, 0
    s_add_u32 s68, s65, 1060864
    s_add_u32 m0, s62, 86016
    s_nop 0
    buffer_load_dwordx4 v255, s[20:23], s68 offen lds
    v_pk_max_i16 v205, v205, 0
    v_pk_max_i16 v206, v206, 0
    v_pk_max_i16 v207, v207, 0
    s_nop 0
    v_permlane16_swap_b32 v204, v206
    s_nop 0
    v_permlane16_swap_b32 v205, v207
    s_movk_i32 s69, 4096
    buffer_store_dwordx4 v[204:207], v248, s[28:31], s69 offen offset:0 sc1
    v_pk_fma_f32 v[52:53], v[192:193], v[24:25], v[52:53] op_sel:[0,0,0] op_sel_hi:[1,0,1]
    v_pk_fma_f32 v[54:55], v[194:195], v[24:25], v[54:55] op_sel:[0,0,0] op_sel_hi:[1,0,1]
    s_add_u32 s68, s65, 1089536
    s_add_u32 m0, s62, 90112
    s_nop 0
    buffer_load_dwordx4 v255, s[20:23], s68 offen lds
    v_pk_fma_f32 v[80:81], v[192:193], v[28:29], v[80:81] op_sel:[0,0,0] op_sel_hi:[1,0,1]
    v_pk_fma_f32 v[82:83], v[194:195], v[28:29], v[82:83] op_sel:[0,0,0] op_sel_hi:[1,0,1]
    v_cvt_pk_bf16_f32 v208, v52, v53
    v_cvt_pk_bf16_f32 v209, v54, v55
    v_cvt_pk_bf16_f32 v210, v80, v81
    v_cvt_pk_bf16_f32 v211, v82, v83
    v_pk_max_i16 v208, v208, 0
    v_pk_max_i16 v209, v209, 0
    v_pk_max_i16 v210, v210, 0
    s_add_u32 s68, s65, 1118208
    s_add_u32 m0, s62, 94208
    s_nop 0
    buffer_load_dwordx4 v255, s[20:23], s68 offen lds
    v_pk_max_i16 v211, v211, 0
    v_permlane16_swap_b32 v208, v210
    s_nop 0
    v_permlane16_swap_b32 v209, v211
    s_movk_i32 s69, 4096
    buffer_store_dwordx4 v[208:211], v248, s[28:31], s69 offen offset:1024 sc1
    v_pk_fma_f32 v[56:57], v[196:197], v[24:25], v[56:57] op_sel:[0,0,0] op_sel_hi:[1,0,1]
    v_pk_fma_f32 v[58:59], v[198:199], v[24:25], v[58:59] op_sel:[0,0,0] op_sel_hi:[1,0,1]
    v_pk_fma_f32 v[84:85], v[196:197], v[28:29], v[84:85] op_sel:[0,0,0] op_sel_hi:[1,0,1]
    v_pk_fma_f32 v[86:87], v[198:199], v[28:29], v[86:87] op_sel:[0,0,0] op_sel_hi:[1,0,1]
    s_add_u32 s68, s65, 1146880
    s_add_u32 m0, s62, 98304
    s_nop 0
    buffer_load_dwordx4 v255, s[20:23], s68 offen lds
    v_cvt_pk_bf16_f32 v200, v56, v57
    v_cvt_pk_bf16_f32 v201, v58, v59
    v_cvt_pk_bf16_f32 v202, v84, v85
    v_cvt_pk_bf16_f32 v203, v86, v87
    v_pk_max_i16 v200, v200, 0
    v_pk_max_i16 v201, v201, 0
    v_pk_max_i16 v202, v202, 0
    v_pk_max_i16 v203, v203, 0
    s_nop 0
    v_permlane16_swap_b32 v200, v202
    s_add_u32 s68, s65, 630784
    s_add_u32 m0, s62, 57344
    s_nop 0
    buffer_load_dwordx4 v255, s[20:23], s68 offen lds
    v_permlane16_swap_b32 v201, v203
    s_movk_i32 s69, 4096
    buffer_store_dwordx4 v[200:203], v248, s[28:31], s69 offen offset:2048 sc1
    s_add_u32 s68, s65, 659456
    s_add_u32 m0, s62, 61440
    s_nop 0
    buffer_load_dwordx4 v255, s[20:23], s68 offen lds
    s_add_u32 s68, s65, 688128
    s_add_u32 m0, s62, 65536
    s_nop 0
    buffer_load_dwordx4 v255, s[20:23], s68 offen lds
    s_add_u32 s68, s65, 716800
    s_add_u32 m0, s62, 69632
    s_nop 0
    buffer_load_dwordx4 v255, s[20:23], s68 offen lds
    s_add_u32 s68, s65, 745472
    s_add_u32 m0, s62, 73728
    s_nop 0
    buffer_load_dwordx4 v255, s[20:23], s68 offen lds
    s_cmp_ge_u32 s33, 14
    s_cbranch_scc1 L_exitC
    s_waitcnt vmcnt(4)
    s_cmp_eq_u32 s37, 1
    s_cbranch_scc0 L_slow_f3
    s_lshl_b32 s40, s32, 12
    s_lshl_b32 s41, s33, 4
    s_add_u32 s40, s40, s41
    s_lshl_b32 s41, s34, 2
    s_add_u32 s40, s40, s41
    s_add_u32 s40, s40, 3072
    v_mov_b32 v20, s35
    s_mov_b64 exec, 1
    buffer_store_dword v20, off, s[28:31], s40
    s_mov_b64 exec, -1
    s_branch L_join_f3
L_slow_f3:
    s_lshl_b32 s40, s32, 12
    s_lshl_b32 s41, s33, 4
    s_add_u32 s40, s40, s41
    s_lshl_b32 s41, s34, 2
    s_add_u32 s40, s40, s41
    s_add_u32 s40, s40, 3072
    v_mov_b32 v20, s35
    s_mov_b64 exec, 1
    buffer_store_dword v20, off, s[28:31], s40 sc1
    s_mov_b64 exec, -1
L_join_f3:
    s_lshl_b32 s68, s32, 12
    s_add_u32 s68, s68, 3072
    v_lshl_add_u32 v9, v0, 2, s68
    buffer_load_dword v10, v9, s[28:31], 0 offen sc1
    s_add_u32 s68, s65, 1548288
    s_add_u32 m0, s62, 155648
    s_nop 0
    buffer_load_dwordx4 v255, s[20:23], s68 offen lds
    s_add_u32 s68, s65, 774144
    s_add_u32 m0, s62, 77824
    s_nop 0
    buffer_load_dwordx4 v255, s[20:23], s68 offen lds
    s_add_u32 s68, s65, 1576960
    s_add_u32 m0, s62, 159744
    s_nop 0
    buffer_load_dwordx4 v255, s[20:23], s68 offen lds
    s_mul_i32 s41, s59, 53248
    s_sub_u32 s41, s41, 102400
    v_add_u32 v224, s41, v250
    v_xor_b32 v225, 64, v224
    v_add_u32 v226, 0x10000, v224
    v_add_u32 v227, 0x10000, v225
    s_lshl_b32 s43, s57, 1
    s_add_u32 s43, s43, s60
    s_lshl_b32 s40, s43, 5
    s_add_u32 s40, s40, s38
    v_and_b32 v19, 31, v0
    v_add_u32 v20, s40, v19
    v_mul_u32_u24 v20, 896, v20
    v_lshrrev_b32 v21, 5, v0
    v_lshl_add_u32 v20, v21, 4, v20
    s_lshl_b32 s40, s58, 7
    s_lshl_b32 s41, s59, 6
    s_add_u32 s40, s40, s41
    v_add_u32 v251, s40, v20
    s_lshl_b32 s40, s32, 13
    s_add_u32 s40, s40, 131072
    s_lshl_b32 s41, s43, 8
    s_add_u32 s40, s40, s41
    v_lshlrev_b32 v20, 3, v19
    v_lshl_add_u32 v20, v21, 12, v20
    v_add_u32 v236, s40, v20
    s_mul_i32 s40, s32, 0x1C000
    s_mul_i32 s41, s43, 28672
    s_add_u32 s40, s40, s41
    s_lshl_b32 s41, s58, 11
    s_add_u32 s40, s40, s41
    s_lshl_b32 s41, s59, 10
    s_add_u32 s40, s40, s41
    s_add_u32 s40, s40, 3145728
    v_bfe_u32 v19, v0, 4, 1
    v_mul_u32_u24 v19, 14336, v19
    v_lshl_add_u32 v20, v21, 4, v17
    v_lshl_add_u32 v19, v20, 4, v19
    v_add_u32 v233, s40, v19
    s_mul_i32 s40, s32, 0x70000
    s_mul_i32 s41, s43, 114688
    s_add_u32 s40, s40, s41
    s_mul_i32 s41, s59, 57344
    s_add_u32 s40, s40, s41
    s_add_u32 s40, s40, 5242880
    v_lshlrev_b32 v22, 4, v0
    v_add_u32 v232, s40, v22
    s_lshl_b32 s40, s62, 2
    v_add_u32 v237, s40, v22
    v_xor_b32 v238, 8192, v237
    buffer_load_dword v11, v9, s[28:31], 0 offen sc1
    buffer_load_dwordx4 v[160:163], v233, s[28:31], 0 offen offset:0 sc1
    buffer_load_dwordx4 v[164:167], v233, s[28:31], 0 offen offset:512 sc1
    buffer_load_dwordx2 v[168:169], v236, s[28:31], 0 offen offset:0 sc1
    buffer_load_dwordx2 v[170:171], v236, s[28:31], 0 offen offset:1024 sc1
    buffer_load_dwordx2 v[172:173], v236, s[28:31], 0 offen offset:2048 sc1
    buffer_load_dwordx2 v[174:175], v236, s[28:31], 0 offen offset:3072 sc1
    s_mov_b32 s44, 0xffffffff
    s_mov_b32 s45, 0xffffffff
    s_waitcnt vmcnt(10)
    v_cmp_eq_u32 vcc, s35, v10
    s_nop 0
    s_and_b64 vcc, vcc, s[44:45]
    s_cmp_eq_u64 vcc, s[44:45]
    s_cbranch_scc1 L_pollok_f3
    s_waitcnt vmcnt(6)
    v_cmp_eq_u32 vcc, s35, v11
    s_nop 0
    s_and_b64 vcc, vcc, s[44:45]
    s_cmp_eq_u64 vcc, s[44:45]
    s_cbranch_scc1 L_pollok_f3
    s_mov_b32 s42, 0
    buffer_load_dword v20, v9, s[28:31], 0 offen sc1
    buffer_load_dword v21, v9, s[28:31], 0 offen sc1
L_poll_f3:
    buffer_load_dword v22, v9, s[28:31], 0 offen sc1
    s_waitcnt vmcnt(2)
    v_cmp_eq_u32 vcc, s35, v20
    s_nop 0
    s_and_b64 vcc, vcc, s[44:45]
    s_cmp_eq_u64 vcc, s[44:45]
    s_cbranch_scc1 L_pollok_f3
    buffer_load_dword v20, v9, s[28:31], 0 offen sc1
    s_waitcnt vmcnt(2)
    v_cmp_eq_u32 vcc, s35, v21
    s_nop 0
    s_and_b64 vcc, vcc, s[44:45]
    s_cmp_eq_u64 vcc, s[44:45]
    s_cbranch_scc1 L_pollok_f3
    buffer_load_dword v21, v9, s[28:31], 0 offen sc1
    s_waitcnt vmcnt(2)
    v_cmp_eq_u32 vcc, s35, v22
    s_nop 0
    s_and_b64 vcc, vcc, s[44:45]
    s_cmp_eq_u64 vcc, s[44:45]
    s_cbranch_scc1 L_pollok_f3
    s_add_u32 s42, s42, 1
    s_cmp_lt_u32 s42, 0x40000
    s_cbranch_scc1 L_poll_f3
L_pollok_f3:
    buffer_load_dwordx4 v[96:99], v232, s[28:31], 0 offen offset:0 sc1
    buffer_load_dwordx4 v[100:103], v232, s[28:31], 0 offen offset:1024 sc1
    buffer_load_dwordx4 v[104:107], v232, s[28:31], 0 offen offset:2048 sc1
    buffer_load_dwordx4 v[108:111], v232, s[28:31], 0 offen offset:3072 sc1
    s_mov_b32 s69, 4096
    buffer_load_dwordx4 v[112:115], v232, s[28:31], s69 offen offset:0 sc1
    buffer_load_dwordx4 v[116:119], v232, s[28:31], s69 offen offset:1024 sc1
    s_waitcnt vmcnt(15)
    s_barrier
    s_mov_b32 s100, 0
    s_mov_b32 s101, -1
    s_waitcnt vmcnt(5)
    v_mfma_f32_32x32x16_bf16 v[32:47], a[0:3], v[96:99], 0
    s_mov_b32 s69, 4096
    v_mfma_f32_32x32x16_bf16 v[48:63], a[4:7], v[96:99], 0
    buffer_load_dwordx4 v[120:123], v232, s[28:31], s69 offen offset:2048 sc1
    buffer_load_dwordx4 v[124:127], v232, s[28:31], s69 offen offset:3072 sc1
    s_waitcnt vmcnt(6)
    v_mfma_f32_32x32x16_bf16 v[32:47], a[8:11], v[100:103], v[32:47]
    s_mov_b32 s69, 8192
    v_mfma_f32_32x32x16_bf16 v[48:63], a[12:15], v[100:103], v[48:63]
    buffer_load_dwordx4 v[128:131], v232, s[28:31], s69 offen offset:0 sc1
    buffer_load_dwordx4 v[132:135], v232, s[28:31], s69 offen offset:1024 sc1
    s_waitcnt vmcnt(7)
    v_mfma_f32_32x32x16_bf16 v[32:47], a[16:19], v[104:107], v[32:47]
    s_mov_b32 s69, 8192
    v_mfma_f32_32x32x16_bf16 v[48:63], a[20:23], v[104:107], v[48:63]
    buffer_load_dwordx4 v[136:139], v232, s[28:31], s69 offen offset:2048 sc1
    buffer_load_dwordx4 v[140:143], v232, s[28:31], s69 offen offset:3072 sc1
    s_waitcnt vmcnt(8)
    v_mfma_f32_32x32x16_bf16 v[32:47], a[24:27], v[108:111], v[32:47]
    s_mov_b32 s69, 12288
    v_mfma_f32_32x32x16_bf16 v[48:63], a[28:31], v[108:111], v[48:63]
    buffer_load_dwordx4 v[144:147], v232, s[28:31], s69 offen offset:0 sc1
    buffer_load_dwordx4 v[148:151], v232, s[28:31], s69 offen offset:1024 sc1
    s_waitcnt vmcnt(9)
    v_mfma_f32_32x32x16_bf16 v[32:47], a[32:35], v[112:115], v[32:47]
    s_mov_b32 s69, 12288
    v_mfma_f32_32x32x16_bf16 v[48:63], a[36:39], v[112:115], v[48:63]
    buffer_load_dwordx4 v[152:155], v232, s[28:31], s69 offen offset:2048 sc1
    buffer_load_dwordx4 v[156:159], v232, s[28:31], s69 offen offset:3072 sc1
    s_waitcnt vmcnt(10)
    v_mfma_f32_32x32x16_bf16 v[32:47], a[40:43], v[116:119], v[32:47]
    s_mov_b32 s69, 16384
    v_mfma_f32_32x32x16_bf16 v[48:63], a[44:47], v[116:119], v[48:63]
    buffer_load_dwordx4 v[96:99], v232, s[28:31], s69 offen offset:0 sc1
    buffer_load_dwordx4 v[100:103], v232, s[28:31], s69 offen offset:1024 sc1
    s_waitcnt vmcnt(11)
    v_mfma_f32_32x32x16_bf16 v[32:47], a[48:51], v[120:123], v[32:47]
    s_mov_b32 s69, 16384
    v_mfma_f32_32x32x16_bf16 v[48:63], a[52:55], v[120:123], v[48:63]
    buffer_load_dwordx4 v[104:107], v232, s[28:31], s69 offen offset:2048 sc1
    buffer_load_dwordx4 v[108:111], v232, s[28:31], s69 offen offset:3072 sc1
    s_waitcnt vmcnt(12)
    v_mfma_f32_32x32x16_bf16 v[32:47], a[56:59], v[124:127], v[32:47]
    s_mov_b32 s69, 20480
    v_mfma_f32_32x32x16_bf16 v[48:63], a[60:63], v[124:127], v[48:63]
    buffer_load_dwordx4 v[112:115], v232, s[28:31], s69 offen offset:0 sc1
    buffer_load_dwordx4 v[116:119], v232, s[28:31], s69 offen offset:1024 sc1
    s_waitcnt vmcnt(13)
    v_mfma_f32_32x32x16_bf16 v[32:47], a[64:67], v[128:131], v[32:47]
    v_mfma_f32_32x32x16_bf16 v[48:63], a[68:71], v[128:131], v[48:63]
    s_mov_b32 s69, 20480
    s_waitcnt vmcnt(12)
    v_mfma_f32_32x32x16_bf16 v[32:47], a[72:75], v[132:135], v[32:47]
    buffer_load_dwordx4 v[120:123], v232, s[28:31], s69 offen offset:2048 sc1
    v_mfma_f32_32x32x16_bf16 v[48:63], a[76:79], v[132:135], v[48:63]
    buffer_load_dwordx4 v[124:127], v232, s[28:31], s69 offen offset:3072 sc1
    s_waitcnt vmcnt(13)
    v_mfma_f32_32x32x16_bf16 v[32:47], a[80:83], v[136:139], v[32:47]
    v_mfma_f32_32x32x16_bf16 v[48:63], a[84:87], v[136:139], v[48:63]
    s_mov_b32 s69, 24576
    s_waitcnt vmcnt(12)
    v_mfma_f32_32x32x16_bf16 v[32:47], a[88:91], v[140:143], v[32:47]
    buffer_load_dwordx4 v[128:131], v232, s[28:31], s69 offen offset:0 sc1
    v_mfma_f32_32x32x16_bf16 v[48:63], a[92:95], v[140:143], v[48:63]
    buffer_load_dwordx4 v[132:135], v232, s[28:31], s69 offen offset:1024 sc1
    s_waitcnt vmcnt(13)
    v_mfma_f32_32x32x16_bf16 v[32:47], a[96:99], v[144:147], v[32:47]
    ds_read_b64_tr_b16 v[208:209], v224 offset:0
    ds_read_b64_tr_b16 v[210:211], v224 offset:512
    v_mfma_f32_32x32x16_bf16 v[48:63], a[100:103], v[144:147], v[48:63]
    ds_read_b64_tr_b16 v[212:213], v225 offset:0
    ds_read_b64_tr_b16 v[214:215], v225 offset:512
    s_mov_b32 s69, 24576
    s_waitcnt vmcnt(12)
    v_mfma_f32_32x32x16_bf16 v[32:47], a[104:107], v[148:151], v[32:47]
    ds_read_b64_tr_b16 v[216:217], v224 offset:2048
    ds_read_b64_tr_b16 v[218:219], v224 offset:2560
    buffer_load_dwordx4 v[136:139], v232, s[28:31], s69 offen offset:2048 sc1
    v_mfma_f32_32x32x16_bf16 v[48:63], a[108:111], v[148:151], v[48:63]
    ds_read_b64_tr_b16 v[220:221], v225 offset:2048
    ds_read_b64_tr_b16 v[222:223], v225 offset:2560
    buffer_load_dwordx4 v[140:143], v232, s[28:31], s69 offen offset:3072 sc1
    s_waitcnt vmcnt(13)
    v_mfma_f32_32x32x16_bf16 v[32:47], a[112:115], v[152:155], v[32:47]
    ds_read_b64_tr_b16 v[64:65], v224 offset:4096
    ds_read_b64_tr_b16 v[66:67], v224 offset:4608
    v_mfma_f32_32x32x16_bf16 v[48:63], a[116:119], v[152:155], v[48:63]
    ds_read_b64_tr_b16 v[68:69], v225 offset:4096
    ds_read_b64_tr_b16 v[70:71], v225 offset:4608
    s_mov_b32 s69, 28672
    s_waitcnt vmcnt(12)
    v_mfma_f32_32x32x16_bf16 v[32:47], a[120:123], v[156:159], v[32:47]
    ds_read_b64_tr_b16 v[72:73], v224 offset:6144
    ds_read_b64_tr_b16 v[74:75], v224 offset:6656
    buffer_load_dwordx4 v[144:147], v232, s[28:31], s69 offen offset:0 sc1
    v_mfma_f32_32x32x16_bf16 v[48:63], a[124:127], v[156:159], v[48:63]
    ds_read_b64_tr_b16 v[76:77], v225 offset:6144
    ds_read_b64_tr_b16 v[78:79], v225 offset:6656
    buffer_load_dwordx4 v[148:151], v232, s[28:31], s69 offen offset:1024 sc1
    s_waitcnt vmcnt(13) lgkmcnt(14)
    v_mfma_f32_32x32x16_bf16 v[32:47], v[208:211], v[96:99], v[32:47]
    ds_read_b64_tr_b16 v[80:81], v224 offset:8192
    ds_read_b64_tr_b16 v[82:83], v224 offset:8704
    s_waitcnt lgkmcnt(14)
    v_mfma_f32_32x32x16_bf16 v[48:63], v[212:215], v[96:99], v[48:63]
    ds_read_b64_tr_b16 v[84:85], v225 offset:8192
    ds_read_b64_tr_b16 v[86:87], v225 offset:8704
    s_mov_b32 s69, 28672
    s_waitcnt vmcnt(12) lgkmcnt(14)
    v_mfma_f32_32x32x16_bf16 v[32:47], v[216:219], v[100:103], v[32:47]
    ds_read_b64_tr_b16 v[88:89], v224 offset:10240
    ds_read_b64_tr_b16 v[90:91], v224 offset:10752
    buffer_load_dwordx4 v[152:155], v232, s[28:31], s69 offen offset:2048 sc1
    s_waitcnt lgkmcnt(14)
    v_mfma_f32_32x32x16_bf16 v[48:63], v[220:223], v[100:103], v[48:63]
    ds_read_b64_tr_b16 v[92:93], v225 offset:10240
    ds_read_b64_tr_b16 v[94:95], v225 offset:10752
    buffer_load_dwordx4 v[156:159], v232, s[28:31], s69 offen offset:3072 sc1
    s_waitcnt vmcnt(13) lgkmcnt(14)
    v_mfma_f32_32x32x16_bf16 v[32:47], v[64:67], v[104:107], v[32:47]
    ds_read_b64_tr_b16 v[208:209], v224 offset:12288
    ds_read_b64_tr_b16 v[210:211], v224 offset:12800
    s_mov_b32 s69, 32768
    buffer_load_dwordx4 v[96:99], v232, s[28:31], s69 offen offset:0 sc1
    s_waitcnt lgkmcnt(14)
    v_mfma_f32_32x32x16_bf16 v[48:63], v[68:71], v[104:107], v[48:63]
    ds_read_b64_tr_b16 v[212:213], v225 offset:12288
    ds_read_b64_tr_b16 v[214:215], v225 offset:12800
    buffer_load_dwordx4 v[100:103], v232, s[28:31], s69 offen offset:1024 sc1
    v_cndmask_b32 v174, v174, 0, s[100:101]
    s_waitcnt vmcnt(14) lgkmcnt(14)
    v_mfma_f32_32x32x16_bf16 v[32:47], v[72:75], v[108:111], v[32:47]
    ds_read_b64_tr_b16 v[216:217], v224 offset:14336
    ds_read_b64_tr_b16 v[218:219], v224 offset:14848
    v_cndmask_b32 v175, v175, 0, s[100:101]
    v_pk_add_f32 v[168:169], v[168:169], v[170:171]
    s_waitcnt lgkmcnt(14)
    v_mfma_f32_32x32x16_bf16 v[48:63], v[76:79], v[108:111], v[48:63]
    ds_read_b64_tr_b16 v[220:221], v225 offset:14336
    ds_read_b64_tr_b16 v[222:223], v225 offset:14848
    v_pk_add_f32 v[172:173], v[172:173], v[174:175]
    v_pk_add_f32 v[168:169], v[168:169], v[172:173]
    s_waitcnt vmcnt(13) lgkmcnt(14)
    v_mfma_f32_32x32x16_bf16 v[32:47], v[80:83], v[112:115], v[32:47]
    ds_read_b64_tr_b16 v[64:65], v224 offset:16384
    ds_read_b64_tr_b16 v[66:67], v224 offset:16896
    s_mov_b32 s69, 32768
    buffer_load_dwordx4 v[104:107], v232, s[28:31], s69 offen offset:2048 sc1
    s_waitcnt lgkmcnt(14)
    v_mfma_f32_32x32x16_bf16 v[48:63], v[84:87], v[112:115], v[48:63]
    ds_read_b64_tr_b16 v[68:69], v225 offset:16384
    ds_read_b64_tr_b16 v[70:71], v225 offset:16896
    buffer_load_dwordx4 v[108:111], v232, s[28:31], s69 offen offset:3072 sc1
    v_mov_b32 v19, v168
    s_waitcnt vmcnt(14) lgkmcnt(14)
    v_mfma_f32_32x32x16_bf16 v[32:47], v[88:91], v[116:119], v[32:47]
    ds_read_b64_tr_b16 v[72:73], v224 offset:18432
    ds_read_b64_tr_b16 v[74:75], v224 offset:18944
    v_mov_b32 v20, v169
    v_permlane32_swap_b32 v168, v19
    s_waitcnt lgkmcnt(14)
    v_mfma_f32_32x32x16_bf16 v[48:63], v[92:95], v[116:119], v[48:63]
    ds_read_b64_tr_b16 v[76:77], v225 offset:18432
    ds_read_b64_tr_b16 v[78:79], v225 offset:18944
    v_permlane32_swap_b32 v169, v20
    v_add_f32 v168, v168, v19
    s_waitcnt vmcnt(13) lgkmcnt(14)
    v_mfma_f32_32x32x16_bf16 v[32:47], v[208:211], v[120:123], v[32:47]
    ds_read_b64_tr_b16 v[80:81], v224 offset:20480
    ds_read_b64_tr_b16 v[82:83], v224 offset:20992
    s_mov_b32 s69, 36864
    buffer_load_dwordx4 v[112:115], v232, s[28:31], s69 offen offset:0 sc1
    s_waitcnt lgkmcnt(14)
    v_mfma_f32_32x32x16_bf16 v[48:63], v[212:215], v[120:123], v[48:63]
    ds_read_b64_tr_b16 v[84:85], v225 offset:20480
    ds_read_b64_tr_b16 v[86:87], v225 offset:20992
    buffer_load_dwordx4 v[116:119], v232, s[28:31], s69 offen offset:1024 sc1
    v_add_f32 v169, v169, v20
    s_waitcnt vmcnt(14) lgkmcnt(14)
    v_mfma_f32_32x32x16_bf16 v[32:47], v[216:219], v[124:127], v[32:47]
    ds_read_b64_tr_b16 v[88:89], v224 offset:22528
    ds_read_b64_tr_b16 v[90:91], v224 offset:23040
    v_mul_f32 v168, -0.002232142857142857, v168
    v_mul_f32 v169, 0.002232142857142857, v169
    s_waitcnt lgkmcnt(14)
    v_mfma_f32_32x32x16_bf16 v[48:63], v[220:223], v[124:127], v[48:63]
    ds_read_b64_tr_b16 v[92:93], v225 offset:22528
    ds_read_b64_tr_b16 v[94:95], v225 offset:23040
    v_fma_f32 v169, -v168, v168, v169
    v_max_f32 v169, 0, v169
    s_waitcnt vmcnt(13) lgkmcnt(14)
    v_mfma_f32_32x32x16_bf16 v[32:47], v[64:67], v[128:131], v[32:47]
    ds_read_b64_tr_b16 v[208:209], v224 offset:24576
    ds_read_b64_tr_b16 v[210:211], v224 offset:25088
    s_mov_b32 s69, 36864
    s_waitcnt lgkmcnt(14)
    v_mfma_f32_32x32x16_bf16 v[48:63], v[68:71], v[128:131], v[48:63]
    ds_read_b64_tr_b16 v[212:213], v225 offset:24576
    ds_read_b64_tr_b16 v[214:215], v225 offset:25088
    buffer_load_dwordx4 v[120:123], v232, s[28:31], s69 offen offset:2048 sc1
    s_waitcnt vmcnt(13) lgkmcnt(14)
    v_mfma_f32_32x32x16_bf16 v[32:47], v[72:75], v[132:135], v[32:47]
    ds_read_b64_tr_b16 v[216:217], v224 offset:26624
    ds_read_b64_tr_b16 v[218:219], v224 offset:27136
    buffer_load_dwordx4 v[124:127], v232, s[28:31], s69 offen offset:3072 sc1
    s_waitcnt lgkmcnt(14)
    v_mfma_f32_32x32x16_bf16 v[48:63], v[76:79], v[132:135], v[48:63]
    ds_read_b64_tr_b16 v[220:221], v225 offset:26624
    ds_read_b64_tr_b16 v[222:223], v225 offset:27136
    v_add_f32 v169, 0x3727c5ac, v169
    v_rsq_f32 v169, v169
    s_waitcnt vmcnt(13) lgkmcnt(14)
    v_mfma_f32_32x32x16_bf16 v[32:47], v[80:83], v[136:139], v[32:47]
    ds_read_b64_tr_b16 v[64:65], v224 offset:28672
    ds_read_b64_tr_b16 v[66:67], v224 offset:29184
    s_waitcnt lgkmcnt(14)
    v_mfma_f32_32x32x16_bf16 v[48:63], v[84:87], v[136:139], v[48:63]
    ds_read_b64_tr_b16 v[68:69], v225 offset:28672
    ds_read_b64_tr_b16 v[70:71], v225 offset:29184
    s_mov_b32 s69, 40960
    s_waitcnt vmcnt(12) lgkmcnt(14)
    v_mfma_f32_32x32x16_bf16 v[32:47], v[88:91], v[140:143], v[32:47]
    ds_read_b64_tr_b16 v[72:73], v224 offset:30720
    ds_read_b64_tr_b16 v[74:75], v224 offset:31232
    buffer_load_dwordx4 v[128:131], v232, s[28:31], s69 offen offset:0 sc1
    s_waitcnt lgkmcnt(14)
    v_mfma_f32_32x32x16_bf16 v[48:63], v[92:95], v[140:143], v[48:63]
    ds_read_b64_tr_b16 v[76:77], v225 offset:30720
    ds_read_b64_tr_b16 v[78:79], v225 offset:31232
    buffer_load_dwordx4 v[132:135], v232, s[28:31], s69 offen offset:1024 sc1
    s_waitcnt vmcnt(13) lgkmcnt(14)
    v_mfma_f32_32x32x16_bf16 v[32:47], v[208:211], v[144:147], v[32:47]
    ds_read_b64_tr_b16 v[80:81], v224 offset:32768
    ds_read_b64_tr_b16 v[82:83], v224 offset:33280
    s_mov_b32 s69, 40960
    s_waitcnt lgkmcnt(14)
    v_mfma_f32_32x32x16_bf16 v[48:63], v[212:215], v[144:147], v[48:63]
    ds_read_b64_tr_b16 v[84:85], v225 offset:32768
    ds_read_b64_tr_b16 v[86:87], v225 offset:33280
    buffer_load_dwordx4 v[136:139], v232, s[28:31], s69 offen offset:2048 sc1
    buffer_load_dwordx4 v[140:143], v232, s[28:31], s69 offen offset:3072 sc1
    s_waitcnt vmcnt(14) lgkmcnt(14)
    v_mfma_f32_32x32x16_bf16 v[32:47], v[216:219], v[148:151], v[32:47]
    ds_read_b64_tr_b16 v[88:89], v224 offset:34816
    ds_read_b64_tr_b16 v[90:91], v224 offset:35328
    v_lshlrev_b32 v192, 16, v160
    v_and_b32 v193, 0xffff0000, v160
    s_waitcnt lgkmcnt(14)
    v_mfma_f32_32x32x16_bf16 v[48:63], v[220:223], v[148:151], v[48:63]
    ds_read_b64_tr_b16 v[92:93], v225 offset:34816
    ds_read_b64_tr_b16 v[94:95], v225 offset:35328
    v_lshlrev_b32 v194, 16, v161
    v_and_b32 v195, 0xffff0000, v161
    s_waitcnt vmcnt(13) lgkmcnt(14)
    v_mfma_f32_32x32x16_bf16 v[32:47], v[64:67], v[152:155], v[32:47]
    ds_read_b64_tr_b16 v[208:209], v224 offset:36864
    ds_read_b64_tr_b16 v[210:211], v224 offset:37376
    s_mov_b32 s69, 45056
    s_waitcnt lgkmcnt(14)
    v_mfma_f32_32x32x16_bf16 v[48:63], v[68:71], v[152:155], v[48:63]
    ds_read_b64_tr_b16 v[212:213], v225 offset:36864
    ds_read_b64_tr_b16 v[214:215], v225 offset:37376
    buffer_load_dwordx4 v[144:147], v232, s[28:31], s69 offen offset:0 sc1
    buffer_load_dwordx4 v[148:151], v232, s[28:31], s69 offen offset:1024 sc1
    s_waitcnt vmcnt(14) lgkmcnt(14)
    v_mfma_f32_32x32x16_bf16 v[32:47], v[72:75], v[156:159], v[32:47]
    ds_read_b64_tr_b16 v[216:217], v224 offset:38912
    ds_read_b64_tr_b16 v[218:219], v224 offset:39424
    v_lshlrev_b32 v196, 16, v164
    v_and_b32 v197, 0xffff0000, v164
    s_waitcnt lgkmcnt(14)
    v_mfma_f32_32x32x16_bf16 v[48:63], v[76:79], v[156:159], v[48:63]
    ds_read_b64_tr_b16 v[220:221], v225 offset:38912
    ds_read_b64_tr_b16 v[222:223], v225 offset:39424
    v_lshlrev_b32 v198, 16, v165
    v_and_b32 v199, 0xffff0000, v165
    s_waitcnt vmcnt(13) lgkmcnt(14)
    v_mfma_f32_32x32x16_bf16 v[32:47], v[80:83], v[96:99], v[32:47]
    ds_read_b64_tr_b16 v[64:65], v224 offset:40960
    ds_read_b64_tr_b16 v[66:67], v224 offset:41472
    s_mov_b32 s69, 45056
    s_waitcnt lgkmcnt(14)
    v_mfma_f32_32x32x16_bf16 v[48:63], v[84:87], v[96:99], v[48:63]
    ds_read_b64_tr_b16 v[68:69], v225 offset:40960
    ds_read_b64_tr_b16 v[70:71], v225 offset:41472
    buffer_load_dwordx4 v[152:155], v232, s[28:31], s69 offen offset:2048 sc1
    buffer_load_dwordx4 v[156:159], v232, s[28:31], s69 offen offset:3072 sc1
    s_waitcnt vmcnt(14) lgkmcnt(14)
    v_mfma_f32_32x32x16_bf16 v[32:47], v[88:91], v[100:103], v[32:47]
    ds_read_b64_tr_b16 v[72:73], v224 offset:43008
    ds_read_b64_tr_b16 v[74:75], v224 offset:43520
    v_lshlrev_b32 v200, 16, v162
    v_and_b32 v201, 0xffff0000, v162
    s_waitcnt lgkmcnt(14)
    v_mfma_f32_32x32x16_bf16 v[48:63], v[92:95], v[100:103], v[48:63]
    ds_read_b64_tr_b16 v[76:77], v225 offset:43008
    ds_read_b64_tr_b16 v[78:79], v225 offset:43520
    v_lshlrev_b32 v202, 16, v163
    v_and_b32 v203, 0xffff0000, v163
    s_waitcnt vmcnt(13) lgkmcnt(14)
    v_mfma_f32_32x32x16_bf16 v[32:47], v[208:211], v[104:107], v[32:47]
    ds_read_b64_tr_b16 v[80:81], v224 offset:45056
    ds_read_b64_tr_b16 v[82:83], v224 offset:45568
    s_mov_b32 s69, 49152
    s_waitcnt lgkmcnt(14)
    v_mfma_f32_32x32x16_bf16 v[48:63], v[212:215], v[104:107], v[48:63]
    ds_read_b64_tr_b16 v[84:85], v225 offset:45056
    ds_read_b64_tr_b16 v[86:87], v225 offset:45568
    buffer_load_dwordx4 v[96:99], v232, s[28:31], s69 offen offset:0 sc1
    buffer_load_dwordx4 v[100:103], v232, s[28:31], s69 offen offset:1024 sc1
    s_waitcnt vmcnt(14) lgkmcnt(14)
    v_mfma_f32_32x32x16_bf16 v[32:47], v[216:219], v[108:111], v[32:47]
    ds_read_b64_tr_b16 v[88:89], v224 offset:47104
    ds_read_b64_tr_b16 v[90:91], v224 offset:47616
    v_lshlrev_b32 v204, 16, v166
    v_and_b32 v205, 0xffff0000, v166
    s_waitcnt lgkmcnt(14)
    v_mfma_f32_32x32x16_bf16 v[48:63], v[220:223], v[108:111], v[48:63]
    ds_read_b64_tr_b16 v[92:93], v225 offset:47104
    ds_read_b64_tr_b16 v[94:95], v225 offset:47616
    v_lshlrev_b32 v206, 16, v167
    v_and_b32 v207, 0xffff0000, v167
    s_waitcnt vmcnt(13) lgkmcnt(14)
    v_mfma_f32_32x32x16_bf16 v[32:47], v[64:67], v[112:115], v[32:47]
    ds_read_b64_tr_b16 v[208:209], v224 offset:49152
    ds_read_b64_tr_b16 v[210:211], v224 offset:49664
    s_waitcnt lgkmcnt(14)
    v_mfma_f32_32x32x16_bf16 v[48:63], v[68:71], v[112:115], v[48:63]
    ds_read_b64_tr_b16 v[212:213], v225 offset:49152
    ds_read_b64_tr_b16 v[214:215], v225 offset:49664
    s_mov_b32 s69, 49152
    s_waitcnt vmcnt(12) lgkmcnt(14)
    v_mfma_f32_32x32x16_bf16 v[32:47], v[72:75], v[116:119], v[32:47]
    ds_read_b64_tr_b16 v[216:217], v224 offset:51200
    ds_read_b64_tr_b16 v[218:219], v224 offset:51712
    buffer_load_dwordx4 v[104:107], v232, s[28:31], s69 offen offset:2048 sc1
    s_waitcnt lgkmcnt(14)
    v_mfma_f32_32x32x16_bf16 v[48:63], v[76:79], v[116:119], v[48:63]
    ds_read_b64_tr_b16 v[220:221], v225 offset:51200
    ds_read_b64_tr_b16 v[222:223], v225 offset:51712
    buffer_load_dwordx4 v[108:111], v232, s[28:31], s69 offen offset:3072 sc1
    s_waitcnt vmcnt(13) lgkmcnt(14)
    v_mfma_f32_32x32x16_bf16 v[32:47], v[80:83], v[120:123], v[32:47]
    ds_read_b64_tr_b16 v[64:65], v224 offset:53248
    ds_read_b64_tr_b16 v[66:67], v224 offset:53760
    s_waitcnt lgkmcnt(14)
    v_mfma_f32_32x32x16_bf16 v[48:63], v[84:87], v[120:123], v[48:63]
    ds_read_b64_tr_b16 v[68:69], v225 offset:53248
    ds_read_b64_tr_b16 v[70:71], v225 offset:53760
    s_mov_b32 s69, 53248
    s_waitcnt vmcnt(12) lgkmcnt(14)
    v_mfma_f32_32x32x16_bf16 v[32:47], v[88:91], v[124:127], v[32:47]
    ds_read_b64_tr_b16 v[72:73], v224 offset:55296
    ds_read_b64_tr_b16 v[74:75], v224 offset:55808
    buffer_load_dwordx4 v[112:115], v232, s[28:31], s69 offen offset:0 sc1
    s_waitcnt lgkmcnt(14)
    v_mfma_f32_32x32x16_bf16 v[48:63], v[92:95], v[124:127], v[48:63]
    ds_read_b64_tr_b16 v[76:77], v225 offset:55296
    ds_read_b64_tr_b16 v[78:79], v225 offset:55808
    buffer_load_dwordx4 v[116:119], v232, s[28:31], s69 offen offset:1024 sc1
    s_waitcnt vmcnt(13) lgkmcnt(14)
    v_mfma_f32_32x32x16_bf16 v[32:47], v[208:211], v[128:131], v[32:47]
    s_barrier
    s_waitcnt lgkmcnt(12)
    v_mfma_f32_32x32x16_bf16 v[48:63], v[212:215], v[128:131], v[48:63]
    ds_read_b64_tr_b16 v[80:81], v224 offset:57344
    ds_read_b64_tr_b16 v[82:83], v224 offset:57856
    s_mov_b32 s69, 53248
    s_waitcnt vmcnt(12) lgkmcnt(12)
    v_mfma_f32_32x32x16_bf16 v[32:47], v[216:219], v[132:135], v[32:47]
    ds_read_b64_tr_b16 v[84:85], v225 offset:57344
    ds_read_b64_tr_b16 v[86:87], v225 offset:57856
    ds_read_b64_tr_b16 v[88:89], v224 offset:59392
    buffer_load_dwordx4 v[120:123], v232, s[28:31], s69 offen offset:2048 sc1
    s_waitcnt lgkmcnt(13)
    v_mfma_f32_32x32x16_bf16 v[48:63], v[220:223], v[132:135], v[48:63]
    ds_read_b64_tr_b16 v[90:91], v224 offset:59904
    ds_read_b64_tr_b16 v[92:93], v225 offset:59392
    ds_read_b64_tr_b16 v[94:95], v225 offset:59904
    buffer_load_dwordx4 v[124:127], v232, s[28:31], s69 offen offset:3072 sc1
    s_waitcnt vmcnt(13) lgkmcnt(14)
    v_mfma_f32_32x32x16_bf16 v[32:47], v[64:67], v[136:139], v[32:47]
    ds_read_b64_tr_b16 v[208:209], v224 offset:61440
    ds_read_b64_tr_b16 v[210:211], v224 offset:61952
    s_waitcnt lgkmcnt(14)
    v_mfma_f32_32x32x16_bf16 v[48:63], v[68:71], v[136:139], v[48:63]
    ds_read_b64_tr_b16 v[212:213], v225 offset:61440
    ds_read_b64_tr_b16 v[214:215], v225 offset:61952
    s_waitcnt vmcnt(12) lgkmcnt(14)
    v_mfma_f32_32x32x16_bf16 v[32:47], v[72:75], v[140:143], v[32:47]
    ds_read_b64_tr_b16 v[216:217], v224 offset:63488
    ds_read_b64_tr_b16 v[218:219], v224 offset:64000
    s_waitcnt lgkmcnt(14)
    v_mfma_f32_32x32x16_bf16 v[48:63], v[76:79], v[140:143], v[48:63]
    ds_read_b64_tr_b16 v[220:221], v225 offset:63488
    ds_read_b64_tr_b16 v[222:223], v225 offset:64000
    s_waitcnt vmcnt(11) lgkmcnt(14)
    v_mfma_f32_32x32x16_bf16 v[32:47], v[80:83], v[144:147], v[32:47]
    ds_read_b64_tr_b16 v[64:65], v226 offset:0
    ds_read_b64_tr_b16 v[66:67], v226 offset:512
    s_waitcnt lgkmcnt(14)
    v_mfma_f32_32x32x16_bf16 v[48:63], v[84:87], v[144:147], v[48:63]
    ds_read_b64_tr_b16 v[68:69], v227 offset:0
    ds_read_b64_tr_b16 v[70:71], v227 offset:512
    s_waitcnt vmcnt(10) lgkmcnt(14)
    v_mfma_f32_32x32x16_bf16 v[32:47], v[88:91], v[148:151], v[32:47]
    ds_read_b64_tr_b16 v[72:73], v226 offset:2048
    ds_read_b64_tr_b16 v[74:75], v226 offset:2560
    s_waitcnt lgkmcnt(14)
    v_mfma_f32_32x32x16_bf16 v[48:63], v[92:95], v[148:151], v[48:63]
    ds_read_b64_tr_b16 v[76:77], v227 offset:2048
    ds_read_b64_tr_b16 v[78:79], v227 offset:2560
    s_waitcnt vmcnt(9) lgkmcnt(14)
    v_mfma_f32_32x32x16_bf16 v[32:47], v[208:211], v[152:155], v[32:47]
    ds_read_b64_tr_b16 v[80:81], v226 offset:4096
    ds_read_b64_tr_b16 v[82:83], v226 offset:4608
    s_waitcnt lgkmcnt(14)
    v_mfma_f32_32x32x16_bf16 v[48:63], v[212:215], v[152:155], v[48:63]
    ds_read_b64_tr_b16 v[84:85], v227 offset:4096
    ds_read_b64_tr_b16 v[86:87], v227 offset:4608
    s_waitcnt vmcnt(8) lgkmcnt(14)
    v_mfma_f32_32x32x16_bf16 v[32:47], v[216:219], v[156:159], v[32:47]
    ds_read_b64_tr_b16 v[88:89], v226 offset:6144
    ds_read_b64_tr_b16 v[90:91], v226 offset:6656
    s_waitcnt lgkmcnt(14)
    v_mfma_f32_32x32x16_bf16 v[48:63], v[220:223], v[156:159], v[48:63]
    ds_read_b64_tr_b16 v[92:93], v227 offset:6144
    ds_read_b64_tr_b16 v[94:95], v227 offset:6656
    s_waitcnt vmcnt(7) lgkmcnt(14)
    v_mfma_f32_32x32x16_bf16 v[32:47], v[64:67], v[96:99], v[32:47]
    ds_read_b64_tr_b16 v[208:209], v226 offset:8192
    ds_read_b64_tr_b16 v[210:211], v226 offset:8704
    s_waitcnt lgkmcnt(14)
    v_mfma_f32_32x32x16_bf16 v[48:63], v[68:71], v[96:99], v[48:63]
    ds_read_b64_tr_b16 v[212:213], v227 offset:8192
    ds_read_b64_tr_b16 v[214:215], v227 offset:8704
    s_waitcnt vmcnt(6) lgkmcnt(14)
    v_mfma_f32_32x32x16_bf16 v[32:47], v[72:75], v[100:103], v[32:47]
    ds_read_b64_tr_b16 v[216:217], v226 offset:10240
    ds_read_b64_tr_b16 v[218:219], v226 offset:10752
    s_waitcnt lgkmcnt(14)
    v_mfma_f32_32x32x16_bf16 v[48:63], v[76:79], v[100:103], v[48:63]
    ds_read_b64_tr_b16 v[220:221], v227 offset:10240
    ds_read_b64_tr_b16 v[222:223], v227 offset:10752
    s_waitcnt vmcnt(5) lgkmcnt(14)
    v_mfma_f32_32x32x16_bf16 v[32:47], v[80:83], v[104:107], v[32:47]
    ds_read_b64_tr_b16 v[64:65], v226 offset:12288
    ds_read_b64_tr_b16 v[66:67], v226 offset:12800
    s_waitcnt lgkmcnt(14)
    v_mfma_f32_32x32x16_bf16 v[48:63], v[84:87], v[104:107], v[48:63]
    ds_read_b64_tr_b16 v[68:69], v227 offset:12288
    ds_read_b64_tr_b16 v[70:71], v227 offset:12800
    s_waitcnt vmcnt(4) lgkmcnt(14)
    v_mfma_f32_32x32x16_bf16 v[32:47], v[88:91], v[108:111], v[32:47]
    ds_read_b64_tr_b16 v[72:73], v226 offset:14336
    ds_read_b64_tr_b16 v[74:75], v226 offset:14848
    s_waitcnt lgkmcnt(14)
    v_mfma_f32_32x32x16_bf16 v[48:63], v[92:95], v[108:111], v[48:63]
    ds_read_b64_tr_b16 v[76:77], v227 offset:14336
    ds_read_b64_tr_b16 v[78:79], v227 offset:14848
    s_waitcnt vmcnt(3) lgkmcnt(14)
    v_mfma_f32_32x32x16_bf16 v[32:47], v[208:211], v[112:115], v[32:47]
    s_waitcnt lgkmcnt(12)
    v_mfma_f32_32x32x16_bf16 v[48:63], v[212:215], v[112:115], v[48:63]
    s_waitcnt vmcnt(2) lgkmcnt(10)
    v_mfma_f32_32x32x16_bf16 v[32:47], v[216:219], v[116:119], v[32:47]
    s_waitcnt lgkmcnt(8)
    v_mfma_f32_32x32x16_bf16 v[48:63], v[220:223], v[116:119], v[48:63]
    s_waitcnt vmcnt(1) lgkmcnt(4)
    v_mfma_f32_32x32x16_bf16 v[48:63], v[68:71], v[120:123], v[48:63]
    s_waitcnt vmcnt(0) lgkmcnt(0)
    v_mfma_f32_32x32x16_bf16 v[48:63], v[76:79], v[124:127], v[48:63]
    v_mfma_f32_32x32x16_bf16 v[32:47], v[64:67], v[120:123], v[32:47]
    v_mfma_f32_32x32x16_bf16 v[32:47], v[72:75], v[124:127], v[32:47]
    s_nop 9
    ds_write_b128 v237, v[48:51] offset:0
    s_nop 8
    ds_write_b128 v237, v[52:55] offset:1024
    s_nop 7
    ds_write_b128 v237, v[56:59] offset:2048
    s_nop 6
    ds_write_b128 v237, v[60:63] offset:3072
    s_waitcnt lgkmcnt(0)
    s_barrier
    ds_read_b128 v[176:179], v238 offset:0
    ds_read_b128 v[180:183], v238 offset:1024
    ds_read_b128 v[184:187], v238 offset:2048
    ds_read_b128 v[188:191], v238 offset:3072
    s_waitcnt lgkmcnt(3)
    s_nop 0
    v_pk_add_f32 v[32:33], v[32:33], v[176:177]
    v_pk_add_f32 v[34:35], v[34:35], v[178:179]
    v_pk_fma_f32 v[32:33], v[32:33], v[168:169], v[192:193] op_sel:[0,1,0] op_sel_hi:[1,1,1]
    v_pk_fma_f32 v[34:35], v[34:35], v[168:169], v[194:195] op_sel:[0,1,0] op_sel_hi:[1,1,1]
    v_cvt_pk_bf16_f32 v96, v32, v33
    v_cvt_pk_bf16_f32 v97, v34, v35
    s_waitcnt lgkmcnt(2)
    v_pk_add_f32 v[36:37], v[36:37], v[180:181]
    v_pk_add_f32 v[38:39], v[38:39], v[182:183]
    v_pk_fma_f32 v[36:37], v[36:37], v[168:169], v[196:197] op_sel:[0,1,0] op_sel_hi:[1,1,1]
    v_pk_fma_f32 v[38:39], v[38:39], v[168:169], v[198:199] op_sel:[0,1,0] op_sel_hi:[1,1,1]
    v_cvt_pk_bf16_f32 v98, v36, v37
    v_cvt_pk_bf16_f32 v99, v38, v39
    s_nop 0
    v_permlane32_swap_b32 v96, v98
    s_nop 0
    v_permlane32_swap_b32 v97, v99
    buffer_store_dwordx4 v[96:99], v251, s[24:27], 0 offen offset:0
    s_waitcnt lgkmcnt(1)
    v_pk_add_f32 v[40:41], v[40:41], v[184:185]
    v_pk_add_f32 v[42:43], v[42:43], v[186:187]
    v_pk_fma_f32 v[40:41], v[40:41], v[168:169], v[200:201] op_sel:[0,1,0] op_sel_hi:[1,1,1]
    v_pk_fma_f32 v[42:43], v[42:43], v[168:169], v[202:203] op_sel:[0,1,0] op_sel_hi:[1,1,1]
    v_cvt_pk_bf16_f32 v100, v40, v41
    v_cvt_pk_bf16_f32 v101, v42, v43
    s_waitcnt lgkmcnt(0)
    v_pk_add_f32 v[44:45], v[44:45], v[188:189]
    v_pk_add_f32 v[46:47], v[46:47], v[190:191]
    v_pk_fma_f32 v[44:45], v[44:45], v[168:169], v[204:205] op_sel:[0,1,0] op_sel_hi:[1,1,1]
    v_pk_fma_f32 v[46:47], v[46:47], v[168:169], v[206:207] op_sel:[0,1,0] op_sel_hi:[1,1,1]
    v_cvt_pk_bf16_f32 v102, v44, v45
    v_cvt_pk_bf16_f32 v103, v46, v47
    s_nop 0
    v_permlane32_swap_b32 v100, v102
    s_nop 0
    v_permlane32_swap_b32 v101, v103
    buffer_store_dwordx4 v[100:103], v251, s[24:27], 0 offen offset:32
    s_waitcnt vmcnt(0)
    s_endpgm
L_exitC:
    s_waitcnt vmcnt(4)
    s_cmp_eq_u32 s37, 1
    s_cbranch_scc0 L_slow_f3x
    s_lshl_b32 s40, s32, 12
    s_lshl_b32 s41, s33, 4
    s_add_u32 s40, s40, s41
    s_lshl_b32 s41, s34, 2
    s_add_u32 s40, s40, s41
    s_add_u32 s40, s40, 3072
    v_mov_b32 v20, s35
    s_mov_b64 exec, 1
    buffer_store_dword v20, off, s[28:31], s40
    s_mov_b64 exec, -1
    s_branch L_join_f3x
L_slow_f3x:
    s_lshl_b32 s40, s32, 12
    s_lshl_b32 s41, s33, 4
    s_add_u32 s40, s40, s41
    s_lshl_b32 s41, s34, 2
    s_add_u32 s40, s40, s41
    s_add_u32 s40, s40, 3072
    v_mov_b32 v20, s35
    s_mov_b64 exec, 1
    buffer_store_dword v20, off, s[28:31], s40 sc1
    s_mov_b64 exec, -1
L_join_f3x:
L_end:
    s_endpgm
L_codeend:

.section .rodata,"a"
.p2align 6
.amdhsa_kernel sequential_preLN__sliding_local_dilated__dense_activation_relu__prompt_kernel
  .amdhsa_next_free_vgpr 512
  .amdhsa_next_free_sgpr 102
  .amdhsa_accum_offset 256
  .amdhsa_group_segment_fixed_size 0
  .amdhsa_kernarg_size 72
  .amdhsa_user_sgpr_count 2
  .amdhsa_user_sgpr_kernarg_segment_ptr 1
  .amdhsa_system_sgpr_workgroup_id_x 1
  .amdhsa_float_denorm_mode_32 3
.end_amdhsa_kernel
```
